```python
import torch

def _softmax(x, axis=-1):
    return torch.softmax(x, dim=axis)
def _gelu(x):
    return torch.nn.functional.gelu(x, approximate="tanh")
def _silu(x):
    return torch.nn.functional.silu(x)
def _sigmoid(x):
    return torch.sigmoid(x)
def _layernorm(x, axis=-1, eps=1e-5):
    m = x.mean(dim=axis, keepdim=True)
    v = x.var(dim=axis, keepdim=True, unbiased=False)
    return (x - m) / torch.sqrt(v + eps)
def _scatter_add(tgt, idx, src, axis=0):
    return tgt.clone().index_add_(axis, idx, src)
def _segment_sum(src, seg, n):
    out = torch.zeros((n,) + src.shape[1:], dtype=src.dtype)
    return out.index_add_(0, seg, src)
def _pad(x, pw):
    flat = tuple(v for pair in reversed(pw) for v in pair)
    return torch.nn.functional.pad(x, flat)

kernel_name = 'gather_scatter__molecular_angular_gemnet__graph'

def setup_inputs():

    _w = (lambda a: (lambda t: t.to(torch.bfloat16) if t.is_floating_point() else t)(torch.as_tensor(a)))
    N, deg, De, L = 10000, 32, 4, 3
    E = N * deg
    T = E * deg
    NR = 8
    dist = torch.rand(E).to(float)
    angle = (torch.rand(T) * torch.pi).to(float)
    centers = torch.linspace(0.0, 1.0, NR).to(float)
    ang_freq = torch.arange(1, L + 1).to(float)
    return {
        "m": _w((lambda *s: torch.randn(*s, dtype=torch.bfloat16) * 0.05)(E, De)),
        "idx_in": _w((lambda lo, hi, *s: torch.randint(lo, hi, s))(0, E, T).to(torch.int64)),
        "idx_out": _w((lambda lo, hi, *s: torch.randint(lo, hi, s))(0, E, T).to(torch.int64)),
        "dist": _w(dist),
        "angle": _w(angle),
        "centers": _w(centers),
        "ang_freq": _w(ang_freq),
        "w_rbf": _w((lambda *s: torch.randn(*s, dtype=torch.bfloat16) * 0.2)(NR, De)),
        "w_sbf": _w((lambda *s: torch.randn(*s, dtype=torch.bfloat16) * 0.2)(NR * L, De)),
        "w_down": _w((lambda *s: torch.randn(*s, dtype=torch.bfloat16) * 0.2)(De, De)),
        "w_up": _w((lambda *s: torch.randn(*s, dtype=torch.bfloat16) * 0.2)(De, De)),
    }

def reference(m, idx_in, idx_out, dist, angle, centers, ang_freq, w_rbf, w_sbf, w_down, w_up):
    E, De = m.shape[0], m.shape[1]
    NR = centers.shape[0]
    L = ang_freq.shape[0]
    rbf = torch.exp(-10.0 * (dist[:, None] - centers[None, :]) ** 2)
    cbf = torch.cos(ang_freq[None, :] * angle[:, None])
    rbf_t = rbf[idx_out]
    sbf = torch.reshape(rbf_t[:, :, None] * cbf[:, None, :], (-1, NR * L))
    x = (m[idx_in] @ w_down) * (sbf @ w_sbf)
    agg = _segment_sum(x, idx_out, E)
    return m + (agg @ w_up) * (rbf @ w_rbf)
```

```asm
; @launch kernel=gs_bin_kernel grid=(256,1,1) block=(1024,1,1) lds=108320
; @launch kernel=gather_scatter__molecular_angular_gemnet__graph_kernel grid=(256,1,1) block=(1024,1,1) lds=133760
.amdgcn_target "amdgcn-amd-amdhsa--gfx950"
.text
.globl gs_bin_kernel
.p2align 8
.type gs_bin_kernel,@function
gs_bin_kernel:
s_cmp_ge_u32 s2, 256
s_cbranch_scc1 L_k1_end
s_getpc_b64 s[20:21]
L_cpf_1:
v_lshlrev_b32 v2, 7, v0
v_cmp_gt_u32 vcc, (L_k1_end-L_cpf_1), v2
s_and_saveexec_b64 s[22:23], vcc
global_load_dword v7, v2, s[20:21]
s_mov_b64 exec, s[22:23]
s_load_dwordx4 s[4:7], s[0:1], 0
s_load_dwordx2 s[8:9], s[0:1], 16
s_load_dwordx2 s[10:11], s[0:1], 32
s_load_dwordx2 s[12:13], s[0:1], 72
s_load_dwordx2 s[14:15], s[0:1], 104
v_lshrrev_b32 v2, 6, v0
v_mov_b32 v1, 1
v_readfirstlane_b32 s90, v2
v_mov_b32 v112, 0
v_mov_b32 v113, 0
v_lshlrev_b32 v114, 3, v0
ds_write_b64 v114, v[112:113]
v_cmp_gt_u32 vcc, 2, v0
s_and_saveexec_b64 s[96:97], vcc
ds_write_b64 v114, v[112:113] offset:8192
s_mov_b64 exec, s[96:97]
s_mov_b32 s88, 53248
s_mov_b32 s89, 11184811
s_mov_b32 s93, -384
s_mov_b32 s3, -210
s_mov_b32 s87, 0xf00000
s_mov_b32 s80, 3435974
s_mov_b32 s81, -1250
s_mov_b32 s82, 16384
s_mov_b32 s83, 32768
s_mov_b32 s84, 49152
s_mov_b32 s85, 65536
s_mov_b32 s86, 81920
s_lshl_b32 s91, s2, 1
s_add_u32 s92, s2, 0
s_mul_i32 s16, s92, 16000
s_lshr_b32 s26, s16, 1
s_add_u32 s92, s2, 256
s_mul_i32 s17, s92, 16000
s_lshr_b32 s27, s17, 1
s_add_u32 s92, s2, 512
s_mul_i32 s18, s92, 16000
s_lshr_b32 s28, s18, 1
s_add_u32 s92, s2, 768
s_mul_i32 s19, s92, 16000
s_lshr_b32 s29, s19, 1
s_add_u32 s92, s2, 1024
s_mul_i32 s20, s92, 16000
s_lshr_b32 s30, s20, 1
s_add_u32 s92, s2, 1280
s_mul_i32 s21, s92, 16000
s_lshr_b32 s31, s21, 1
s_add_u32 s92, s2, 1536
s_mul_i32 s22, s92, 16000
s_lshr_b32 s32, s22, 1
s_add_u32 s92, s2, 1792
s_mul_i32 s23, s92, 16000
s_lshr_b32 s33, s23, 1
s_add_u32 s92, s2, 2048
s_mul_i32 s24, s92, 16000
s_lshr_b32 s34, s24, 1
s_add_u32 s92, s2, 2304
s_mul_i32 s25, s92, 16000
s_lshr_b32 s35, s25, 1
v_lshlrev_b32 v4, 4, v0
v_lshlrev_b32 v5, 3, v0
v_add_u32 v6, 65536, v4
v_cmp_gt_u32 vcc, 1000, v0
s_mov_b64 s[94:95], vcc
s_waitcnt lgkmcnt(0)
s_load_dwordx8 s[56:63], s[12:13], 0
s_mov_b32 s36, s8
s_and_b32 s37, s9, 0xffff
s_mov_b32 s38, 40960000
s_mov_b32 s39, 0x20000
s_mov_b32 s40, s6
s_and_b32 s41, s7, 0xffff
s_mov_b32 s42, 40960000
s_mov_b32 s43, 0x20000
s_mov_b32 s44, s10
s_and_b32 s45, s11, 0xffff
s_mov_b32 s46, 20480000
s_mov_b32 s47, 0x20000
s_mov_b32 s48, s4
s_and_b32 s49, s5, 0xffff
s_mov_b32 s50, 2560000
s_mov_b32 s51, 0x20000
s_mov_b32 s52, s14
s_and_b32 s53, s15, 0xffff
s_mov_b32 s54, 2560000
s_mov_b32 s55, 0x20000
s_add_u32 s72, s14, 2621440
s_addc_u32 s73, s15, 0
s_and_b32 s73, s73, 0xffff
s_mov_b32 s74, 2097152
s_mov_b32 s75, 0x20000
s_mul_i32 s92, s2, 10000
v_lshl_add_u32 v2, v0, 3, s92
v_add_u32 v3, 8192, v2
buffer_load_dwordx2 v[108:109], v2, s[48:51], 0 offen
buffer_load_dwordx2 v[110:111], v3, s[48:51], 0 offen
s_mov_b64 exec, s[94:95]
buffer_load_dwordx4 v[8:11], v4, s[36:39], s16 offen nt
buffer_load_dwordx4 v[28:31], v4, s[40:43], s16 offen nt
buffer_load_dwordx2 v[48:49], v5, s[44:47], s26 offen nt
buffer_load_dwordx4 v[12:15], v4, s[36:39], s17 offen nt
buffer_load_dwordx4 v[32:35], v4, s[40:43], s17 offen nt
buffer_load_dwordx2 v[50:51], v5, s[44:47], s27 offen nt
s_mov_b64 exec, -1
s_waitcnt lgkmcnt(0)
s_barrier
s_waitcnt vmcnt(6)
v_lshlrev_b32 v112, 16, v108
v_and_b32 v113, 0xffff0000, v108
v_lshlrev_b32 v114, 16, v109
v_and_b32 v115, 0xffff0000, v109
s_lshl_b32 s92, s56, 16
v_mul_f32 v116, s92, v112
s_lshl_b32 s92, s58, 16
v_fmac_f32 v116, s92, v113
s_lshl_b32 s92, s60, 16
v_fmac_f32 v116, s92, v114
s_lshl_b32 s92, s62, 16
v_fmac_f32 v116, s92, v115
s_and_b32 s92, s56, 0xffff0000
v_mul_f32 v117, s92, v112
s_and_b32 s92, s58, 0xffff0000
v_fmac_f32 v117, s92, v113
s_and_b32 s92, s60, 0xffff0000
v_fmac_f32 v117, s92, v114
s_and_b32 s92, s62, 0xffff0000
v_fmac_f32 v117, s92, v115
s_lshl_b32 s92, s57, 16
v_mul_f32 v118, s92, v112
s_lshl_b32 s92, s59, 16
v_fmac_f32 v118, s92, v113
s_lshl_b32 s92, s61, 16
v_fmac_f32 v118, s92, v114
s_lshl_b32 s92, s63, 16
v_fmac_f32 v118, s92, v115
s_and_b32 s92, s57, 0xffff0000
v_mul_f32 v119, s92, v112
s_and_b32 s92, s59, 0xffff0000
v_fmac_f32 v119, s92, v113
s_and_b32 s92, s61, 0xffff0000
v_fmac_f32 v119, s92, v114
s_and_b32 s92, s63, 0xffff0000
v_fmac_f32 v119, s92, v115
v_cvt_pk_bf16_f32 v120, v116, v117
v_cvt_pk_bf16_f32 v121, v118, v119
v_lshlrev_b32 v112, 16, v110
v_and_b32 v113, 0xffff0000, v110
v_lshlrev_b32 v114, 16, v111
v_and_b32 v115, 0xffff0000, v111
s_lshl_b32 s92, s56, 16
v_mul_f32 v116, s92, v112
s_lshl_b32 s92, s58, 16
v_fmac_f32 v116, s92, v113
s_lshl_b32 s92, s60, 16
v_fmac_f32 v116, s92, v114
s_lshl_b32 s92, s62, 16
v_fmac_f32 v116, s92, v115
s_and_b32 s92, s56, 0xffff0000
v_mul_f32 v117, s92, v112
s_and_b32 s92, s58, 0xffff0000
v_fmac_f32 v117, s92, v113
s_and_b32 s92, s60, 0xffff0000
v_fmac_f32 v117, s92, v114
s_and_b32 s92, s62, 0xffff0000
v_fmac_f32 v117, s92, v115
s_lshl_b32 s92, s57, 16
v_mul_f32 v118, s92, v112
s_lshl_b32 s92, s59, 16
v_fmac_f32 v118, s92, v113
s_lshl_b32 s92, s61, 16
v_fmac_f32 v118, s92, v114
s_lshl_b32 s92, s63, 16
v_fmac_f32 v118, s92, v115
s_and_b32 s92, s57, 0xffff0000
v_mul_f32 v119, s92, v112
s_and_b32 s92, s59, 0xffff0000
v_fmac_f32 v119, s92, v113
s_and_b32 s92, s61, 0xffff0000
v_fmac_f32 v119, s92, v114
s_and_b32 s92, s63, 0xffff0000
v_fmac_f32 v119, s92, v115
v_cvt_pk_bf16_f32 v122, v116, v117
v_cvt_pk_bf16_f32 v123, v118, v119
buffer_store_dwordx2 v[120:121], v2, s[52:55], 0 offen
v_cmp_gt_u32 vcc, 226, v0
s_and_saveexec_b64 s[96:97], vcc
buffer_store_dwordx2 v[122:123], v3, s[52:55], 0 offen
s_mov_b64 exec, s[96:97]
s_mov_b32 s92, 0x7fff0000
v_lshlrev_b32 v112, 16, v120
v_and_b32 v112, s92, v112
v_lshlrev_b32 v116, 16, v122
v_and_b32 v116, s92, v116
v_max_u32 v112, v112, v116
v_and_b32 v113, s92, v120
v_and_b32 v116, s92, v122
v_max_u32 v113, v113, v116
v_lshlrev_b32 v114, 16, v121
v_and_b32 v114, s92, v114
v_lshlrev_b32 v116, 16, v123
v_and_b32 v116, s92, v116
v_max_u32 v114, v114, v116
v_and_b32 v115, s92, v121
v_and_b32 v116, s92, v123
v_max_u32 v115, v115, v116
s_nop 0
v_max_u32_dpp v112, v112, v112 row_shr:1 row_mask:0xf bank_mask:0xf bound_ctrl:0
v_max_u32_dpp v113, v113, v113 row_shr:1 row_mask:0xf bank_mask:0xf bound_ctrl:0
v_max_u32_dpp v114, v114, v114 row_shr:1 row_mask:0xf bank_mask:0xf bound_ctrl:0
v_max_u32_dpp v115, v115, v115 row_shr:1 row_mask:0xf bank_mask:0xf bound_ctrl:0
s_nop 0
v_max_u32_dpp v112, v112, v112 row_shr:2 row_mask:0xf bank_mask:0xf bound_ctrl:0
v_max_u32_dpp v113, v113, v113 row_shr:2 row_mask:0xf bank_mask:0xf bound_ctrl:0
v_max_u32_dpp v114, v114, v114 row_shr:2 row_mask:0xf bank_mask:0xf bound_ctrl:0
v_max_u32_dpp v115, v115, v115 row_shr:2 row_mask:0xf bank_mask:0xf bound_ctrl:0
s_nop 0
v_max_u32_dpp v112, v112, v112 row_shr:4 row_mask:0xf bank_mask:0xf bound_ctrl:0
v_max_u32_dpp v113, v113, v113 row_shr:4 row_mask:0xf bank_mask:0xf bound_ctrl:0
v_max_u32_dpp v114, v114, v114 row_shr:4 row_mask:0xf bank_mask:0xf bound_ctrl:0
v_max_u32_dpp v115, v115, v115 row_shr:4 row_mask:0xf bank_mask:0xf bound_ctrl:0
s_nop 0
v_max_u32_dpp v112, v112, v112 row_shr:8 row_mask:0xf bank_mask:0xf bound_ctrl:0
v_max_u32_dpp v113, v113, v113 row_shr:8 row_mask:0xf bank_mask:0xf bound_ctrl:0
v_max_u32_dpp v114, v114, v114 row_shr:8 row_mask:0xf bank_mask:0xf bound_ctrl:0
v_max_u32_dpp v115, v115, v115 row_shr:8 row_mask:0xf bank_mask:0xf bound_ctrl:0
s_nop 0
v_max_u32_dpp v112, v112, v112 row_bcast:15 row_mask:0xa bank_mask:0xf
v_max_u32_dpp v113, v113, v113 row_bcast:15 row_mask:0xa bank_mask:0xf
v_max_u32_dpp v114, v114, v114 row_bcast:15 row_mask:0xa bank_mask:0xf
v_max_u32_dpp v115, v115, v115 row_bcast:15 row_mask:0xa bank_mask:0xf
s_nop 0
v_max_u32_dpp v112, v112, v112 row_bcast:31 row_mask:0xc bank_mask:0xf
v_max_u32_dpp v113, v113, v113 row_bcast:31 row_mask:0xc bank_mask:0xf
v_max_u32_dpp v114, v114, v114 row_bcast:31 row_mask:0xc bank_mask:0xf
v_max_u32_dpp v115, v115, v115 row_bcast:31 row_mask:0xc bank_mask:0xf
v_and_b32 v116, 63, v0
v_cmp_eq_u32 vcc, 63, v116
s_and_saveexec_b64 s[96:97], vcc
v_mov_b32 v116, 0
ds_max_u32 v116, v112 offset:8192
ds_max_u32 v116, v113 offset:8196
ds_max_u32 v116, v114 offset:8200
ds_max_u32 v116, v115 offset:8204
s_mov_b64 exec, s[96:97]
s_mov_b64 exec, s[94:95]
s_waitcnt vmcnt(4)
buffer_load_dwordx4 v[16:19], v4, s[36:39], s18 offen nt
buffer_load_dwordx4 v[36:39], v4, s[40:43], s18 offen nt
buffer_load_dwordx2 v[52:53], v5, s[44:47], s28 offen nt
v_mul_hi_u32_u24 v2, s80, v8
v_mul_hi_u32_u24 v7, s88, v28
v_mad_i32_i24 v3, v2, s81, v8
v_mul_hi_u32_u24 v8, s89, v28
v_lshl_add_u32 v2, v2, 2, v7
v_mad_i32_i24 v28, v8, s93, v28
v_mad_i32_i24 v7, v7, s3, v8
v_lshl_or_b32 v28, v3, 9, v28
v_lshlrev_b32 v8, 2, v2
v_lshl_or_b32 v28, v7, 24, v28
ds_add_rtn_u32 v108, v8, v1 offset:0
v_mul_hi_u32_u24 v2, s80, v9
v_mul_hi_u32_u24 v7, s88, v29
v_mad_i32_i24 v3, v2, s81, v9
v_mul_hi_u32_u24 v9, s89, v29
v_lshl_add_u32 v2, v2, 2, v7
v_mad_i32_i24 v29, v9, s93, v29
v_mad_i32_i24 v7, v7, s3, v9
v_lshl_or_b32 v29, v3, 9, v29
v_lshlrev_b32 v9, 2, v2
v_lshl_or_b32 v29, v7, 24, v29
ds_add_rtn_u32 v109, v9, v1 offset:0
v_mul_hi_u32_u24 v2, s80, v10
v_mul_hi_u32_u24 v7, s88, v30
v_mad_i32_i24 v3, v2, s81, v10
v_mul_hi_u32_u24 v10, s89, v30
v_lshl_add_u32 v2, v2, 2, v7
v_mad_i32_i24 v30, v10, s93, v30
v_mad_i32_i24 v7, v7, s3, v10
v_lshl_or_b32 v30, v3, 9, v30
v_lshlrev_b32 v10, 2, v2
v_lshl_or_b32 v30, v7, 24, v30
ds_add_rtn_u32 v110, v10, v1 offset:0
v_mul_hi_u32_u24 v2, s80, v11
v_mul_hi_u32_u24 v7, s88, v31
v_mad_i32_i24 v3, v2, s81, v11
v_mul_hi_u32_u24 v11, s89, v31
v_lshl_add_u32 v2, v2, 2, v7
v_mad_i32_i24 v31, v11, s93, v31
v_mad_i32_i24 v7, v7, s3, v11
v_lshl_or_b32 v31, v3, 9, v31
v_lshlrev_b32 v11, 2, v2
v_lshl_or_b32 v31, v7, 24, v31
ds_add_rtn_u32 v111, v11, v1 offset:0
s_waitcnt vmcnt(4)
buffer_load_dwordx4 v[20:23], v4, s[36:39], s19 offen nt
buffer_load_dwordx4 v[40:43], v4, s[40:43], s19 offen nt
buffer_load_dwordx2 v[54:55], v5, s[44:47], s29 offen nt
v_mul_hi_u32_u24 v2, s80, v12
v_mul_hi_u32_u24 v7, s88, v32
v_mad_i32_i24 v3, v2, s81, v12
v_mul_hi_u32_u24 v12, s89, v32
v_lshl_add_u32 v2, v2, 2, v7
v_mad_i32_i24 v32, v12, s93, v32
v_mad_i32_i24 v7, v7, s3, v12
v_lshl_or_b32 v32, v3, 9, v32
v_lshlrev_b32 v12, 2, v2
v_lshl_or_b32 v32, v7, 24, v32
ds_add_rtn_u32 v112, v12, v1 offset:0
v_mul_hi_u32_u24 v2, s80, v13
v_mul_hi_u32_u24 v7, s88, v33
v_mad_i32_i24 v3, v2, s81, v13
v_mul_hi_u32_u24 v13, s89, v33
v_lshl_add_u32 v2, v2, 2, v7
v_mad_i32_i24 v33, v13, s93, v33
v_mad_i32_i24 v7, v7, s3, v13
v_lshl_or_b32 v33, v3, 9, v33
v_lshlrev_b32 v13, 2, v2
v_lshl_or_b32 v33, v7, 24, v33
ds_add_rtn_u32 v113, v13, v1 offset:0
v_mul_hi_u32_u24 v2, s80, v14
v_mul_hi_u32_u24 v7, s88, v34
v_mad_i32_i24 v3, v2, s81, v14
v_mul_hi_u32_u24 v14, s89, v34
v_lshl_add_u32 v2, v2, 2, v7
v_mad_i32_i24 v34, v14, s93, v34
v_mad_i32_i24 v7, v7, s3, v14
v_lshl_or_b32 v34, v3, 9, v34
v_lshlrev_b32 v14, 2, v2
v_lshl_or_b32 v34, v7, 24, v34
ds_add_rtn_u32 v114, v14, v1 offset:0
v_mul_hi_u32_u24 v2, s80, v15
v_mul_hi_u32_u24 v7, s88, v35
v_mad_i32_i24 v3, v2, s81, v15
v_mul_hi_u32_u24 v15, s89, v35
v_lshl_add_u32 v2, v2, 2, v7
v_mad_i32_i24 v35, v15, s93, v35
v_mad_i32_i24 v7, v7, s3, v15
v_lshl_or_b32 v35, v3, 9, v35
v_lshlrev_b32 v15, 2, v2
v_lshl_or_b32 v35, v7, 24, v35
ds_add_rtn_u32 v115, v15, v1 offset:0
v_lshlrev_b32 v2, 16, v48
v_and_b32 v3, 0xffff0000, v48
v_mul_f32 v2, 0.15915494, v2
v_mul_f32 v3, 0.15915494, v3
v_fract_f32 v2, v2
v_fract_f32 v3, v3
v_cvt_pknorm_u16_f32 v48, v2, v3
v_lshlrev_b32 v2, 16, v48
v_and_or_b32 v29, v48, s87, v29
v_and_or_b32 v28, v2, s87, v28
v_lshrrev_b32 v48, 8, v48
v_lshlrev_b32 v2, 16, v49
v_and_b32 v3, 0xffff0000, v49
v_mul_f32 v2, 0.15915494, v2
v_mul_f32 v3, 0.15915494, v3
v_fract_f32 v2, v2
v_fract_f32 v3, v3
v_cvt_pknorm_u16_f32 v49, v2, v3
v_lshlrev_b32 v2, 16, v49
v_and_or_b32 v31, v49, s87, v31
v_and_or_b32 v30, v2, s87, v30
v_lshrrev_b32 v49, 8, v49
s_waitcnt vmcnt(4)
buffer_load_dwordx4 v[24:27], v4, s[36:39], s20 offen nt
buffer_load_dwordx4 v[44:47], v4, s[40:43], s20 offen nt
buffer_load_dwordx2 v[56:57], v5, s[44:47], s30 offen nt
v_mul_hi_u32_u24 v2, s80, v16
v_mul_hi_u32_u24 v7, s88, v36
v_mad_i32_i24 v3, v2, s81, v16
v_mul_hi_u32_u24 v16, s89, v36
v_lshl_add_u32 v2, v2, 2, v7
v_mad_i32_i24 v36, v16, s93, v36
v_mad_i32_i24 v7, v7, s3, v16
v_lshl_or_b32 v36, v3, 9, v36
v_lshlrev_b32 v16, 2, v2
v_lshl_or_b32 v36, v7, 24, v36
ds_add_rtn_u32 v116, v16, v1 offset:0
v_mul_hi_u32_u24 v2, s80, v17
v_mul_hi_u32_u24 v7, s88, v37
v_mad_i32_i24 v3, v2, s81, v17
v_mul_hi_u32_u24 v17, s89, v37
v_lshl_add_u32 v2, v2, 2, v7
v_mad_i32_i24 v37, v17, s93, v37
v_mad_i32_i24 v7, v7, s3, v17
v_lshl_or_b32 v37, v3, 9, v37
v_lshlrev_b32 v17, 2, v2
v_lshl_or_b32 v37, v7, 24, v37
ds_add_rtn_u32 v117, v17, v1 offset:0
v_mul_hi_u32_u24 v2, s80, v18
v_mul_hi_u32_u24 v7, s88, v38
v_mad_i32_i24 v3, v2, s81, v18
v_mul_hi_u32_u24 v18, s89, v38
v_lshl_add_u32 v2, v2, 2, v7
v_mad_i32_i24 v38, v18, s93, v38
v_mad_i32_i24 v7, v7, s3, v18
v_lshl_or_b32 v38, v3, 9, v38
v_lshlrev_b32 v18, 2, v2
v_lshl_or_b32 v38, v7, 24, v38
ds_add_rtn_u32 v118, v18, v1 offset:0
v_mul_hi_u32_u24 v2, s80, v19
v_mul_hi_u32_u24 v7, s88, v39
v_mad_i32_i24 v3, v2, s81, v19
v_mul_hi_u32_u24 v19, s89, v39
v_lshl_add_u32 v2, v2, 2, v7
v_mad_i32_i24 v39, v19, s93, v39
v_mad_i32_i24 v7, v7, s3, v19
v_lshl_or_b32 v39, v3, 9, v39
v_lshlrev_b32 v19, 2, v2
v_lshl_or_b32 v39, v7, 24, v39
ds_add_rtn_u32 v119, v19, v1 offset:0
v_lshlrev_b32 v2, 16, v50
v_and_b32 v3, 0xffff0000, v50
v_mul_f32 v2, 0.15915494, v2
v_mul_f32 v3, 0.15915494, v3
v_fract_f32 v2, v2
v_fract_f32 v3, v3
v_cvt_pknorm_u16_f32 v50, v2, v3
v_lshlrev_b32 v2, 16, v50
v_and_or_b32 v33, v50, s87, v33
v_and_or_b32 v32, v2, s87, v32
v_lshrrev_b32 v50, 8, v50
v_lshlrev_b32 v2, 16, v51
v_and_b32 v3, 0xffff0000, v51
v_mul_f32 v2, 0.15915494, v2
v_mul_f32 v3, 0.15915494, v3
v_fract_f32 v2, v2
v_fract_f32 v3, v3
v_cvt_pknorm_u16_f32 v51, v2, v3
v_lshlrev_b32 v2, 16, v51
v_and_or_b32 v35, v51, s87, v35
v_and_or_b32 v34, v2, s87, v34
v_lshrrev_b32 v51, 8, v51
s_waitcnt vmcnt(4)
v_mul_hi_u32_u24 v2, s80, v20
v_mul_hi_u32_u24 v7, s88, v40
v_mad_i32_i24 v3, v2, s81, v20
v_mul_hi_u32_u24 v20, s89, v40
v_lshl_add_u32 v2, v2, 2, v7
v_mad_i32_i24 v40, v20, s93, v40
v_mad_i32_i24 v7, v7, s3, v20
v_lshl_or_b32 v40, v3, 9, v40
v_lshlrev_b32 v20, 2, v2
v_lshl_or_b32 v40, v7, 24, v40
s_waitcnt lgkmcnt(11)
ds_add_rtn_u32 v120, v20, v1 offset:0
v_mul_hi_u32_u24 v2, s80, v21
v_mul_hi_u32_u24 v7, s88, v41
v_mad_i32_i24 v3, v2, s81, v21
v_mul_hi_u32_u24 v21, s89, v41
v_lshl_add_u32 v2, v2, 2, v7
v_mad_i32_i24 v41, v21, s93, v41
v_mad_i32_i24 v7, v7, s3, v21
v_lshl_or_b32 v41, v3, 9, v41
v_lshlrev_b32 v21, 2, v2
v_lshl_or_b32 v41, v7, 24, v41
ds_add_rtn_u32 v121, v21, v1 offset:0
v_mul_hi_u32_u24 v2, s80, v22
v_mul_hi_u32_u24 v7, s88, v42
v_mad_i32_i24 v3, v2, s81, v22
v_mul_hi_u32_u24 v22, s89, v42
v_lshl_add_u32 v2, v2, 2, v7
v_mad_i32_i24 v42, v22, s93, v42
v_mad_i32_i24 v7, v7, s3, v22
v_lshl_or_b32 v42, v3, 9, v42
v_lshlrev_b32 v22, 2, v2
v_lshl_or_b32 v42, v7, 24, v42
ds_add_rtn_u32 v122, v22, v1 offset:0
v_mul_hi_u32_u24 v2, s80, v23
v_mul_hi_u32_u24 v7, s88, v43
v_mad_i32_i24 v3, v2, s81, v23
v_mul_hi_u32_u24 v23, s89, v43
v_lshl_add_u32 v2, v2, 2, v7
v_mad_i32_i24 v43, v23, s93, v43
v_mad_i32_i24 v7, v7, s3, v23
v_lshl_or_b32 v43, v3, 9, v43
v_lshlrev_b32 v23, 2, v2
v_lshl_or_b32 v43, v7, 24, v43
ds_add_rtn_u32 v123, v23, v1 offset:0
v_lshlrev_b32 v2, 16, v52
v_and_b32 v3, 0xffff0000, v52
v_mul_f32 v2, 0.15915494, v2
v_mul_f32 v3, 0.15915494, v3
v_fract_f32 v2, v2
v_fract_f32 v3, v3
v_cvt_pknorm_u16_f32 v52, v2, v3
v_lshlrev_b32 v2, 16, v52
v_and_or_b32 v37, v52, s87, v37
v_and_or_b32 v36, v2, s87, v36
v_lshrrev_b32 v52, 8, v52
v_lshlrev_b32 v2, 16, v53
v_and_b32 v3, 0xffff0000, v53
v_mul_f32 v2, 0.15915494, v2
v_mul_f32 v3, 0.15915494, v3
v_fract_f32 v2, v2
v_fract_f32 v3, v3
v_cvt_pknorm_u16_f32 v53, v2, v3
v_lshlrev_b32 v2, 16, v53
v_and_or_b32 v39, v53, s87, v39
v_and_or_b32 v38, v2, s87, v38
v_lshrrev_b32 v53, 8, v53
s_waitcnt vmcnt(1)
v_mul_hi_u32_u24 v2, s80, v24
v_mul_hi_u32_u24 v7, s88, v44
v_mad_i32_i24 v3, v2, s81, v24
v_mul_hi_u32_u24 v24, s89, v44
v_lshl_add_u32 v2, v2, 2, v7
v_mad_i32_i24 v44, v24, s93, v44
v_mad_i32_i24 v7, v7, s3, v24
v_lshl_or_b32 v44, v3, 9, v44
v_lshlrev_b32 v24, 2, v2
v_lshl_or_b32 v44, v7, 24, v44
s_waitcnt lgkmcnt(11)
ds_add_rtn_u32 v124, v24, v1 offset:0
v_mul_hi_u32_u24 v2, s80, v25
v_mul_hi_u32_u24 v7, s88, v45
v_mad_i32_i24 v3, v2, s81, v25
v_mul_hi_u32_u24 v25, s89, v45
v_lshl_add_u32 v2, v2, 2, v7
v_mad_i32_i24 v45, v25, s93, v45
v_mad_i32_i24 v7, v7, s3, v25
v_lshl_or_b32 v45, v3, 9, v45
v_lshlrev_b32 v25, 2, v2
v_lshl_or_b32 v45, v7, 24, v45
ds_add_rtn_u32 v125, v25, v1 offset:0
v_mul_hi_u32_u24 v2, s80, v26
v_mul_hi_u32_u24 v7, s88, v46
v_mad_i32_i24 v3, v2, s81, v26
v_mul_hi_u32_u24 v26, s89, v46
v_lshl_add_u32 v2, v2, 2, v7
v_mad_i32_i24 v46, v26, s93, v46
v_mad_i32_i24 v7, v7, s3, v26
v_lshl_or_b32 v46, v3, 9, v46
v_lshlrev_b32 v26, 2, v2
v_lshl_or_b32 v46, v7, 24, v46
ds_add_rtn_u32 v126, v26, v1 offset:0
v_mul_hi_u32_u24 v2, s80, v27
v_mul_hi_u32_u24 v7, s88, v47
v_mad_i32_i24 v3, v2, s81, v27
v_mul_hi_u32_u24 v27, s89, v47
v_lshl_add_u32 v2, v2, 2, v7
v_mad_i32_i24 v47, v27, s93, v47
v_mad_i32_i24 v7, v7, s3, v27
v_lshl_or_b32 v47, v3, 9, v47
v_lshlrev_b32 v27, 2, v2
v_lshl_or_b32 v47, v7, 24, v47
ds_add_rtn_u32 v127, v27, v1 offset:0
v_lshlrev_b32 v2, 16, v54
v_and_b32 v3, 0xffff0000, v54
v_mul_f32 v2, 0.15915494, v2
v_mul_f32 v3, 0.15915494, v3
v_fract_f32 v2, v2
v_fract_f32 v3, v3
v_cvt_pknorm_u16_f32 v54, v2, v3
v_lshlrev_b32 v2, 16, v54
v_and_or_b32 v41, v54, s87, v41
v_and_or_b32 v40, v2, s87, v40
v_lshrrev_b32 v54, 8, v54
v_lshlrev_b32 v2, 16, v55
v_and_b32 v3, 0xffff0000, v55
v_mul_f32 v2, 0.15915494, v2
v_mul_f32 v3, 0.15915494, v3
v_fract_f32 v2, v2
v_fract_f32 v3, v3
v_cvt_pknorm_u16_f32 v55, v2, v3
v_lshlrev_b32 v2, 16, v55
v_and_or_b32 v43, v55, s87, v43
v_and_or_b32 v42, v2, s87, v42
v_lshrrev_b32 v55, 8, v55
s_waitcnt vmcnt(0)
v_lshlrev_b32 v2, 16, v56
v_and_b32 v3, 0xffff0000, v56
v_mul_f32 v2, 0.15915494, v2
v_mul_f32 v3, 0.15915494, v3
v_fract_f32 v2, v2
v_fract_f32 v3, v3
v_cvt_pknorm_u16_f32 v56, v2, v3
v_lshlrev_b32 v2, 16, v56
v_and_or_b32 v45, v56, s87, v45
v_and_or_b32 v44, v2, s87, v44
v_lshrrev_b32 v56, 8, v56
v_lshlrev_b32 v2, 16, v57
v_and_b32 v3, 0xffff0000, v57
v_mul_f32 v2, 0.15915494, v2
v_mul_f32 v3, 0.15915494, v3
v_fract_f32 v2, v2
v_fract_f32 v3, v3
v_cvt_pknorm_u16_f32 v57, v2, v3
v_lshlrev_b32 v2, 16, v57
v_and_or_b32 v47, v57, s87, v47
v_and_or_b32 v46, v2, s87, v46
v_lshrrev_b32 v57, 8, v57
s_mov_b64 exec, -1
s_waitcnt vmcnt(0) lgkmcnt(0)
s_barrier
s_cmp_lg_u32 s90, 1
s_cbranch_scc1 L_mmax_skip_2
s_mov_b64 exec, 15
v_and_b32 v2, 3, v0
v_lshlrev_b32 v2, 2, v2
ds_read_b32 v3, v2 offset:8192
s_lshl_b32 s92, s2, 4
s_add_u32 s92, s92, 4718592
s_add_u32 s76, s14, s92
s_addc_u32 s77, s15, 0
s_and_b32 s77, s77, 0xffff
s_mov_b32 s78, 16
s_mov_b32 s79, 0x20000
s_waitcnt lgkmcnt(0)
buffer_store_dword v3, v2, s[76:79], 0 offen
s_mov_b64 exec, -1
L_mmax_skip_2:
s_cmp_lg_u32 s90, 0
s_cbranch_scc1 L_scan_skip_3
v_lshlrev_b32 v90, 6, v0
ds_read_b128 v[58:61], v90 offset:0
ds_read_b128 v[62:65], v90 offset:16
ds_read_b128 v[66:69], v90 offset:32
ds_read_b128 v[70:73], v90 offset:48
s_waitcnt lgkmcnt(0)
v_mov_b32 v74, 0
v_add_u32 v75, v74, v58
v_add_u32 v76, v75, v59
v_add_u32 v77, v76, v60
v_add_u32 v78, v77, v61
v_add_u32 v79, v78, v62
v_add_u32 v80, v79, v63
v_add_u32 v81, v80, v64
v_add_u32 v82, v81, v65
v_add_u32 v83, v82, v66
v_add_u32 v84, v83, v67
v_add_u32 v85, v84, v68
v_add_u32 v86, v85, v69
v_add_u32 v87, v86, v70
v_add_u32 v88, v87, v71
v_add_u32 v89, v88, v72
v_add_u32 v91, v89, v73
v_mov_b32 v92, v91
s_nop 1
v_add_u32_dpp v91, v91, v91 row_shr:1 row_mask:0xf bank_mask:0xf bound_ctrl:0
s_nop 1
v_add_u32_dpp v91, v91, v91 row_shr:2 row_mask:0xf bank_mask:0xf bound_ctrl:0
s_nop 1
v_add_u32_dpp v91, v91, v91 row_shr:4 row_mask:0xf bank_mask:0xf bound_ctrl:0
s_nop 1
v_add_u32_dpp v91, v91, v91 row_shr:8 row_mask:0xf bank_mask:0xf bound_ctrl:0
s_nop 1
v_add_u32_dpp v91, v91, v91 row_bcast:15 row_mask:0xa bank_mask:0xf
s_nop 1
v_add_u32_dpp v91, v91, v91 row_bcast:31 row_mask:0xc bank_mask:0xf
v_sub_u32 v91, v91, v92
v_add_u32 v74, v74, v91
v_lshl_or_b32 v58, v58, 16, v74
v_add_u32 v75, v75, v91
v_lshl_or_b32 v59, v59, 16, v75
v_add_u32 v76, v76, v91
v_lshl_or_b32 v60, v60, 16, v76
v_add_u32 v77, v77, v91
v_lshl_or_b32 v61, v61, 16, v77
v_add_u32 v78, v78, v91
v_lshl_or_b32 v62, v62, 16, v78
v_add_u32 v79, v79, v91
v_lshl_or_b32 v63, v63, 16, v79
v_add_u32 v80, v80, v91
v_lshl_or_b32 v64, v64, 16, v80
v_add_u32 v81, v81, v91
v_lshl_or_b32 v65, v65, 16, v81
v_add_u32 v82, v82, v91
v_lshl_or_b32 v66, v66, 16, v82
v_add_u32 v83, v83, v91
v_lshl_or_b32 v67, v67, 16, v83
v_add_u32 v84, v84, v91
v_lshl_or_b32 v68, v68, 16, v84
v_add_u32 v85, v85, v91
v_lshl_or_b32 v69, v69, 16, v85
v_add_u32 v86, v86, v91
v_lshl_or_b32 v70, v70, 16, v86
v_add_u32 v87, v87, v91
v_lshl_or_b32 v71, v71, 16, v87
v_add_u32 v88, v88, v91
v_lshl_or_b32 v72, v72, 16, v88
v_add_u32 v89, v89, v91
v_lshl_or_b32 v73, v73, 16, v89
s_lshl_b32 s92, s91, 12
buffer_store_dwordx4 v[58:61], v90, s[72:75], s92 offen offset:0
ds_write_b128 v90, v[74:77] offset:0
buffer_store_dwordx4 v[62:65], v90, s[72:75], s92 offen offset:16
ds_write_b128 v90, v[78:81] offset:16
buffer_store_dwordx4 v[66:69], v90, s[72:75], s92 offen offset:32
ds_write_b128 v90, v[82:85] offset:32
buffer_store_dwordx4 v[70:73], v90, s[72:75], s92 offen offset:48
ds_write_b128 v90, v[86:89] offset:48
s_waitcnt lgkmcnt(0)
L_scan_skip_3:
s_barrier
s_mov_b64 exec, s[94:95]
ds_read_b32 v8, v8 offset:0
ds_read_b32 v9, v9 offset:0
ds_read_b32 v10, v10 offset:0
ds_read_b32 v11, v11 offset:0
ds_read_b32 v12, v12 offset:0
ds_read_b32 v13, v13 offset:0
ds_read_b32 v14, v14 offset:0
ds_read_b32 v15, v15 offset:0
s_waitcnt lgkmcnt(4)
v_add_u32 v8, v8, v108
v_lshrrev_b32 v2, 2, v8
v_add_lshl_u32 v3, v8, v2, 2
v_lshl_add_u32 v2, v2, 4, v8
ds_write_b32 v3, v28 offset:8256
ds_write_b8 v2, v48 offset:8272
v_add_u32 v9, v9, v109
v_lshrrev_b32 v2, 2, v9
v_add_lshl_u32 v3, v9, v2, 2
v_lshl_add_u32 v2, v2, 4, v9
ds_write_b32 v3, v29 offset:8256
ds_write_b8_d16_hi v2, v48 offset:8272
buffer_load_dwordx4 v[58:61], v4, s[36:39], s21 offen nt
v_add_u32 v10, v10, v110
v_lshrrev_b32 v2, 2, v10
v_add_lshl_u32 v3, v10, v2, 2
v_lshl_add_u32 v2, v2, 4, v10
ds_write_b32 v3, v30 offset:8256
ds_write_b8 v2, v49 offset:8272
v_add_u32 v11, v11, v111
v_lshrrev_b32 v2, 2, v11
v_add_lshl_u32 v3, v11, v2, 2
v_lshl_add_u32 v2, v2, 4, v11
ds_write_b32 v3, v31 offset:8256
ds_write_b8_d16_hi v2, v49 offset:8272
s_waitcnt lgkmcnt(8)
ds_read_b32 v16, v16 offset:0
ds_read_b32 v17, v17 offset:0
ds_read_b32 v18, v18 offset:0
ds_read_b32 v19, v19 offset:0
s_waitcnt lgkmcnt(4)
v_add_u32 v12, v12, v112
v_lshrrev_b32 v2, 2, v12
v_add_lshl_u32 v3, v12, v2, 2
v_lshl_add_u32 v2, v2, 4, v12
ds_write_b32 v3, v32 offset:8256
ds_write_b8 v2, v50 offset:8272
buffer_load_dwordx4 v[78:81], v4, s[40:43], s21 offen nt
v_add_u32 v13, v13, v113
v_lshrrev_b32 v2, 2, v13
v_add_lshl_u32 v3, v13, v2, 2
v_lshl_add_u32 v2, v2, 4, v13
ds_write_b32 v3, v33 offset:8256
ds_write_b8_d16_hi v2, v50 offset:8272
v_add_u32 v14, v14, v114
v_lshrrev_b32 v2, 2, v14
v_add_lshl_u32 v3, v14, v2, 2
v_lshl_add_u32 v2, v2, 4, v14
ds_write_b32 v3, v34 offset:8256
ds_write_b8 v2, v51 offset:8272
v_add_u32 v15, v15, v115
v_lshrrev_b32 v2, 2, v15
v_add_lshl_u32 v3, v15, v2, 2
v_lshl_add_u32 v2, v2, 4, v15
ds_write_b32 v3, v35 offset:8256
ds_write_b8_d16_hi v2, v51 offset:8272
buffer_load_dwordx2 v[98:99], v5, s[44:47], s31 offen nt
s_waitcnt lgkmcnt(8)
ds_read_b32 v20, v20 offset:0
ds_read_b32 v21, v21 offset:0
ds_read_b32 v22, v22 offset:0
ds_read_b32 v23, v23 offset:0
s_waitcnt lgkmcnt(4)
v_add_u32 v16, v16, v116
v_lshrrev_b32 v2, 2, v16
v_add_lshl_u32 v3, v16, v2, 2
v_lshl_add_u32 v2, v2, 4, v16
ds_write_b32 v3, v36 offset:8256
ds_write_b8 v2, v52 offset:8272
v_add_u32 v17, v17, v117
v_lshrrev_b32 v2, 2, v17
v_add_lshl_u32 v3, v17, v2, 2
v_lshl_add_u32 v2, v2, 4, v17
ds_write_b32 v3, v37 offset:8256
ds_write_b8_d16_hi v2, v52 offset:8272
v_add_u32 v18, v18, v118
v_lshrrev_b32 v2, 2, v18
v_add_lshl_u32 v3, v18, v2, 2
v_lshl_add_u32 v2, v2, 4, v18
ds_write_b32 v3, v38 offset:8256
ds_write_b8 v2, v53 offset:8272
buffer_load_dwordx4 v[62:65], v4, s[36:39], s22 offen nt
v_add_u32 v19, v19, v119
v_lshrrev_b32 v2, 2, v19
v_add_lshl_u32 v3, v19, v2, 2
v_lshl_add_u32 v2, v2, 4, v19
ds_write_b32 v3, v39 offset:8256
ds_write_b8_d16_hi v2, v53 offset:8272
s_waitcnt lgkmcnt(8)
ds_read_b32 v24, v24 offset:0
ds_read_b32 v25, v25 offset:0
ds_read_b32 v26, v26 offset:0
ds_read_b32 v27, v27 offset:0
s_waitcnt lgkmcnt(4)
v_add_u32 v20, v20, v120
v_lshrrev_b32 v2, 2, v20
v_add_lshl_u32 v3, v20, v2, 2
v_lshl_add_u32 v2, v2, 4, v20
ds_write_b32 v3, v40 offset:8256
ds_write_b8 v2, v54 offset:8272
v_add_u32 v21, v21, v121
v_lshrrev_b32 v2, 2, v21
v_add_lshl_u32 v3, v21, v2, 2
v_lshl_add_u32 v2, v2, 4, v21
ds_write_b32 v3, v41 offset:8256
ds_write_b8_d16_hi v2, v54 offset:8272
buffer_load_dwordx4 v[82:85], v4, s[40:43], s22 offen nt
v_add_u32 v22, v22, v122
v_lshrrev_b32 v2, 2, v22
v_add_lshl_u32 v3, v22, v2, 2
v_lshl_add_u32 v2, v2, 4, v22
ds_write_b32 v3, v42 offset:8256
ds_write_b8 v2, v55 offset:8272
v_add_u32 v23, v23, v123
v_lshrrev_b32 v2, 2, v23
v_add_lshl_u32 v3, v23, v2, 2
v_lshl_add_u32 v2, v2, 4, v23
ds_write_b32 v3, v43 offset:8256
ds_write_b8_d16_hi v2, v55 offset:8272
s_waitcnt lgkmcnt(0)
v_add_u32 v24, v24, v124
v_lshrrev_b32 v2, 2, v24
v_add_lshl_u32 v3, v24, v2, 2
v_lshl_add_u32 v2, v2, 4, v24
ds_write_b32 v3, v44 offset:8256
ds_write_b8 v2, v56 offset:8272
buffer_load_dwordx2 v[100:101], v5, s[44:47], s32 offen nt
v_add_u32 v25, v25, v125
v_lshrrev_b32 v2, 2, v25
v_add_lshl_u32 v3, v25, v2, 2
v_lshl_add_u32 v2, v2, 4, v25
ds_write_b32 v3, v45 offset:8256
ds_write_b8_d16_hi v2, v56 offset:8272
v_add_u32 v26, v26, v126
v_lshrrev_b32 v2, 2, v26
v_add_lshl_u32 v3, v26, v2, 2
v_lshl_add_u32 v2, v2, 4, v26
ds_write_b32 v3, v46 offset:8256
ds_write_b8 v2, v57 offset:8272
v_add_u32 v27, v27, v127
v_lshrrev_b32 v2, 2, v27
v_add_lshl_u32 v3, v27, v2, 2
v_lshl_add_u32 v2, v2, 4, v27
ds_write_b32 v3, v47 offset:8256
ds_write_b8_d16_hi v2, v57 offset:8272
s_mov_b64 exec, -1
s_waitcnt lgkmcnt(0)
s_barrier
s_mul_i32 s92, s91, 100000
s_add_u32 s92, s92, 5242880
s_add_u32 s76, s14, s92
s_addc_u32 s77, s15, 0
s_and_b32 s77, s77, 0xffff
s_mov_b32 s78, 100000
s_mov_b32 s79, 0x20000
ds_read_b128 v[8:11], v4 offset:8256
ds_read_b128 v[12:15], v4 offset:24640
ds_read_b128 v[16:19], v4 offset:41024
ds_read_b128 v[20:23], v4 offset:57408
ds_read_b128 v[24:27], v6 offset:8256
ds_read_b128 v[28:31], v6 offset:24640
ds_read_b128 v[32:35], v6 offset:41024
s_waitcnt lgkmcnt(0)
s_add_u32 s91, s91, 1
s_mov_b64 exec, s[94:95]
s_waitcnt vmcnt(4)
buffer_load_dwordx4 v[66:69], v4, s[36:39], s23 offen nt
buffer_load_dwordx4 v[86:89], v4, s[40:43], s23 offen nt
buffer_load_dwordx2 v[102:103], v5, s[44:47], s33 offen nt
v_mul_hi_u32_u24 v2, s80, v58
v_mul_hi_u32_u24 v7, s88, v78
v_mad_i32_i24 v3, v2, s81, v58
v_mul_hi_u32_u24 v58, s89, v78
v_lshl_add_u32 v2, v2, 2, v7
v_mad_i32_i24 v78, v58, s93, v78
v_mad_i32_i24 v7, v7, s3, v58
v_lshl_or_b32 v78, v3, 9, v78
v_lshlrev_b32 v58, 2, v2
v_lshl_or_b32 v78, v7, 24, v78
ds_add_rtn_u32 v108, v58, v1 offset:4096
v_mul_hi_u32_u24 v2, s80, v59
v_mul_hi_u32_u24 v7, s88, v79
v_mad_i32_i24 v3, v2, s81, v59
v_mul_hi_u32_u24 v59, s89, v79
v_lshl_add_u32 v2, v2, 2, v7
v_mad_i32_i24 v79, v59, s93, v79
v_mad_i32_i24 v7, v7, s3, v59
v_lshl_or_b32 v79, v3, 9, v79
v_lshlrev_b32 v59, 2, v2
v_lshl_or_b32 v79, v7, 24, v79
ds_add_rtn_u32 v109, v59, v1 offset:4096
v_mul_hi_u32_u24 v2, s80, v60
v_mul_hi_u32_u24 v7, s88, v80
v_mad_i32_i24 v3, v2, s81, v60
v_mul_hi_u32_u24 v60, s89, v80
v_lshl_add_u32 v2, v2, 2, v7
v_mad_i32_i24 v80, v60, s93, v80
v_mad_i32_i24 v7, v7, s3, v60
v_lshl_or_b32 v80, v3, 9, v80
v_lshlrev_b32 v60, 2, v2
v_lshl_or_b32 v80, v7, 24, v80
ds_add_rtn_u32 v110, v60, v1 offset:4096
v_mul_hi_u32_u24 v2, s80, v61
v_mul_hi_u32_u24 v7, s88, v81
v_mad_i32_i24 v3, v2, s81, v61
v_mul_hi_u32_u24 v61, s89, v81
v_lshl_add_u32 v2, v2, 2, v7
v_mad_i32_i24 v81, v61, s93, v81
v_mad_i32_i24 v7, v7, s3, v61
v_lshl_or_b32 v81, v3, 9, v81
v_lshlrev_b32 v61, 2, v2
v_lshl_or_b32 v81, v7, 24, v81
ds_add_rtn_u32 v111, v61, v1 offset:4096
s_waitcnt vmcnt(4)
buffer_load_dwordx4 v[70:73], v4, s[36:39], s24 offen nt
buffer_load_dwordx4 v[90:93], v4, s[40:43], s24 offen nt
buffer_load_dwordx2 v[104:105], v5, s[44:47], s34 offen nt
v_mul_hi_u32_u24 v2, s80, v62
v_mul_hi_u32_u24 v7, s88, v82
v_mad_i32_i24 v3, v2, s81, v62
v_mul_hi_u32_u24 v62, s89, v82
v_lshl_add_u32 v2, v2, 2, v7
v_mad_i32_i24 v82, v62, s93, v82
v_mad_i32_i24 v7, v7, s3, v62
v_lshl_or_b32 v82, v3, 9, v82
v_lshlrev_b32 v62, 2, v2
v_lshl_or_b32 v82, v7, 24, v82
ds_add_rtn_u32 v112, v62, v1 offset:4096
v_mul_hi_u32_u24 v2, s80, v63
v_mul_hi_u32_u24 v7, s88, v83
v_mad_i32_i24 v3, v2, s81, v63
v_mul_hi_u32_u24 v63, s89, v83
v_lshl_add_u32 v2, v2, 2, v7
v_mad_i32_i24 v83, v63, s93, v83
v_mad_i32_i24 v7, v7, s3, v63
v_lshl_or_b32 v83, v3, 9, v83
v_lshlrev_b32 v63, 2, v2
v_lshl_or_b32 v83, v7, 24, v83
ds_add_rtn_u32 v113, v63, v1 offset:4096
v_mul_hi_u32_u24 v2, s80, v64
v_mul_hi_u32_u24 v7, s88, v84
v_mad_i32_i24 v3, v2, s81, v64
v_mul_hi_u32_u24 v64, s89, v84
v_lshl_add_u32 v2, v2, 2, v7
v_mad_i32_i24 v84, v64, s93, v84
v_mad_i32_i24 v7, v7, s3, v64
v_lshl_or_b32 v84, v3, 9, v84
v_lshlrev_b32 v64, 2, v2
v_lshl_or_b32 v84, v7, 24, v84
ds_add_rtn_u32 v114, v64, v1 offset:4096
v_mul_hi_u32_u24 v2, s80, v65
v_mul_hi_u32_u24 v7, s88, v85
v_mad_i32_i24 v3, v2, s81, v65
v_mul_hi_u32_u24 v65, s89, v85
v_lshl_add_u32 v2, v2, 2, v7
v_mad_i32_i24 v85, v65, s93, v85
v_mad_i32_i24 v7, v7, s3, v65
v_lshl_or_b32 v85, v3, 9, v85
v_lshlrev_b32 v65, 2, v2
v_lshl_or_b32 v85, v7, 24, v85
ds_add_rtn_u32 v115, v65, v1 offset:4096
v_lshlrev_b32 v2, 16, v98
v_and_b32 v3, 0xffff0000, v98
v_mul_f32 v2, 0.15915494, v2
v_mul_f32 v3, 0.15915494, v3
v_fract_f32 v2, v2
v_fract_f32 v3, v3
v_cvt_pknorm_u16_f32 v98, v2, v3
v_lshlrev_b32 v2, 16, v98
v_and_or_b32 v79, v98, s87, v79
v_and_or_b32 v78, v2, s87, v78
v_lshrrev_b32 v98, 8, v98
v_lshlrev_b32 v2, 16, v99
v_and_b32 v3, 0xffff0000, v99
v_mul_f32 v2, 0.15915494, v2
v_mul_f32 v3, 0.15915494, v3
v_fract_f32 v2, v2
v_fract_f32 v3, v3
v_cvt_pknorm_u16_f32 v99, v2, v3
v_lshlrev_b32 v2, 16, v99
v_and_or_b32 v81, v99, s87, v81
v_and_or_b32 v80, v2, s87, v80
v_lshrrev_b32 v99, 8, v99
s_waitcnt vmcnt(4)
buffer_load_dwordx4 v[74:77], v4, s[36:39], s25 offen nt
buffer_load_dwordx4 v[94:97], v4, s[40:43], s25 offen nt
buffer_load_dwordx2 v[106:107], v5, s[44:47], s35 offen nt
v_mul_hi_u32_u24 v2, s80, v66
v_mul_hi_u32_u24 v7, s88, v86
v_mad_i32_i24 v3, v2, s81, v66
v_mul_hi_u32_u24 v66, s89, v86
v_lshl_add_u32 v2, v2, 2, v7
v_mad_i32_i24 v86, v66, s93, v86
v_mad_i32_i24 v7, v7, s3, v66
v_lshl_or_b32 v86, v3, 9, v86
v_lshlrev_b32 v66, 2, v2
v_lshl_or_b32 v86, v7, 24, v86
ds_add_rtn_u32 v116, v66, v1 offset:4096
v_mul_hi_u32_u24 v2, s80, v67
v_mul_hi_u32_u24 v7, s88, v87
v_mad_i32_i24 v3, v2, s81, v67
v_mul_hi_u32_u24 v67, s89, v87
v_lshl_add_u32 v2, v2, 2, v7
v_mad_i32_i24 v87, v67, s93, v87
v_mad_i32_i24 v7, v7, s3, v67
v_lshl_or_b32 v87, v3, 9, v87
v_lshlrev_b32 v67, 2, v2
v_lshl_or_b32 v87, v7, 24, v87
ds_add_rtn_u32 v117, v67, v1 offset:4096
v_mul_hi_u32_u24 v2, s80, v68
v_mul_hi_u32_u24 v7, s88, v88
v_mad_i32_i24 v3, v2, s81, v68
v_mul_hi_u32_u24 v68, s89, v88
v_lshl_add_u32 v2, v2, 2, v7
v_mad_i32_i24 v88, v68, s93, v88
v_mad_i32_i24 v7, v7, s3, v68
v_lshl_or_b32 v88, v3, 9, v88
v_lshlrev_b32 v68, 2, v2
v_lshl_or_b32 v88, v7, 24, v88
ds_add_rtn_u32 v118, v68, v1 offset:4096
v_mul_hi_u32_u24 v2, s80, v69
v_mul_hi_u32_u24 v7, s88, v89
v_mad_i32_i24 v3, v2, s81, v69
v_mul_hi_u32_u24 v69, s89, v89
v_lshl_add_u32 v2, v2, 2, v7
v_mad_i32_i24 v89, v69, s93, v89
v_mad_i32_i24 v7, v7, s3, v69
v_lshl_or_b32 v89, v3, 9, v89
v_lshlrev_b32 v69, 2, v2
v_lshl_or_b32 v89, v7, 24, v89
ds_add_rtn_u32 v119, v69, v1 offset:4096
v_lshlrev_b32 v2, 16, v100
v_and_b32 v3, 0xffff0000, v100
v_mul_f32 v2, 0.15915494, v2
v_mul_f32 v3, 0.15915494, v3
v_fract_f32 v2, v2
v_fract_f32 v3, v3
v_cvt_pknorm_u16_f32 v100, v2, v3
v_lshlrev_b32 v2, 16, v100
v_and_or_b32 v83, v100, s87, v83
v_and_or_b32 v82, v2, s87, v82
v_lshrrev_b32 v100, 8, v100
v_lshlrev_b32 v2, 16, v101
v_and_b32 v3, 0xffff0000, v101
v_mul_f32 v2, 0.15915494, v2
v_mul_f32 v3, 0.15915494, v3
v_fract_f32 v2, v2
v_fract_f32 v3, v3
v_cvt_pknorm_u16_f32 v101, v2, v3
v_lshlrev_b32 v2, 16, v101
v_and_or_b32 v85, v101, s87, v85
v_and_or_b32 v84, v2, s87, v84
v_lshrrev_b32 v101, 8, v101
s_waitcnt vmcnt(4)
v_mul_hi_u32_u24 v2, s80, v70
v_mul_hi_u32_u24 v7, s88, v90
v_mad_i32_i24 v3, v2, s81, v70
v_mul_hi_u32_u24 v70, s89, v90
v_lshl_add_u32 v2, v2, 2, v7
v_mad_i32_i24 v90, v70, s93, v90
v_mad_i32_i24 v7, v7, s3, v70
v_lshl_or_b32 v90, v3, 9, v90
v_lshlrev_b32 v70, 2, v2
v_lshl_or_b32 v90, v7, 24, v90
s_waitcnt lgkmcnt(11)
ds_add_rtn_u32 v120, v70, v1 offset:4096
v_mul_hi_u32_u24 v2, s80, v71
v_mul_hi_u32_u24 v7, s88, v91
v_mad_i32_i24 v3, v2, s81, v71
v_mul_hi_u32_u24 v71, s89, v91
v_lshl_add_u32 v2, v2, 2, v7
v_mad_i32_i24 v91, v71, s93, v91
v_mad_i32_i24 v7, v7, s3, v71
v_lshl_or_b32 v91, v3, 9, v91
v_lshlrev_b32 v71, 2, v2
v_lshl_or_b32 v91, v7, 24, v91
ds_add_rtn_u32 v121, v71, v1 offset:4096
v_mul_hi_u32_u24 v2, s80, v72
v_mul_hi_u32_u24 v7, s88, v92
v_mad_i32_i24 v3, v2, s81, v72
v_mul_hi_u32_u24 v72, s89, v92
v_lshl_add_u32 v2, v2, 2, v7
v_mad_i32_i24 v92, v72, s93, v92
v_mad_i32_i24 v7, v7, s3, v72
v_lshl_or_b32 v92, v3, 9, v92
v_lshlrev_b32 v72, 2, v2
v_lshl_or_b32 v92, v7, 24, v92
ds_add_rtn_u32 v122, v72, v1 offset:4096
v_mul_hi_u32_u24 v2, s80, v73
v_mul_hi_u32_u24 v7, s88, v93
v_mad_i32_i24 v3, v2, s81, v73
v_mul_hi_u32_u24 v73, s89, v93
v_lshl_add_u32 v2, v2, 2, v7
v_mad_i32_i24 v93, v73, s93, v93
v_mad_i32_i24 v7, v7, s3, v73
v_lshl_or_b32 v93, v3, 9, v93
v_lshlrev_b32 v73, 2, v2
v_lshl_or_b32 v93, v7, 24, v93
ds_add_rtn_u32 v123, v73, v1 offset:4096
v_lshlrev_b32 v2, 16, v102
v_and_b32 v3, 0xffff0000, v102
v_mul_f32 v2, 0.15915494, v2
v_mul_f32 v3, 0.15915494, v3
v_fract_f32 v2, v2
v_fract_f32 v3, v3
v_cvt_pknorm_u16_f32 v102, v2, v3
v_lshlrev_b32 v2, 16, v102
v_and_or_b32 v87, v102, s87, v87
v_and_or_b32 v86, v2, s87, v86
v_lshrrev_b32 v102, 8, v102
v_lshlrev_b32 v2, 16, v103
v_and_b32 v3, 0xffff0000, v103
v_mul_f32 v2, 0.15915494, v2
v_mul_f32 v3, 0.15915494, v3
v_fract_f32 v2, v2
v_fract_f32 v3, v3
v_cvt_pknorm_u16_f32 v103, v2, v3
v_lshlrev_b32 v2, 16, v103
v_and_or_b32 v89, v103, s87, v89
v_and_or_b32 v88, v2, s87, v88
v_lshrrev_b32 v103, 8, v103
s_waitcnt vmcnt(1)
v_mul_hi_u32_u24 v2, s80, v74
v_mul_hi_u32_u24 v7, s88, v94
v_mad_i32_i24 v3, v2, s81, v74
v_mul_hi_u32_u24 v74, s89, v94
v_lshl_add_u32 v2, v2, 2, v7
v_mad_i32_i24 v94, v74, s93, v94
v_mad_i32_i24 v7, v7, s3, v74
v_lshl_or_b32 v94, v3, 9, v94
v_lshlrev_b32 v74, 2, v2
v_lshl_or_b32 v94, v7, 24, v94
s_waitcnt lgkmcnt(11)
ds_add_rtn_u32 v124, v74, v1 offset:4096
v_mul_hi_u32_u24 v2, s80, v75
v_mul_hi_u32_u24 v7, s88, v95
v_mad_i32_i24 v3, v2, s81, v75
v_mul_hi_u32_u24 v75, s89, v95
v_lshl_add_u32 v2, v2, 2, v7
v_mad_i32_i24 v95, v75, s93, v95
v_mad_i32_i24 v7, v7, s3, v75
v_lshl_or_b32 v95, v3, 9, v95
v_lshlrev_b32 v75, 2, v2
v_lshl_or_b32 v95, v7, 24, v95
ds_add_rtn_u32 v125, v75, v1 offset:4096
v_mul_hi_u32_u24 v2, s80, v76
v_mul_hi_u32_u24 v7, s88, v96
v_mad_i32_i24 v3, v2, s81, v76
v_mul_hi_u32_u24 v76, s89, v96
v_lshl_add_u32 v2, v2, 2, v7
v_mad_i32_i24 v96, v76, s93, v96
v_mad_i32_i24 v7, v7, s3, v76
v_lshl_or_b32 v96, v3, 9, v96
v_lshlrev_b32 v76, 2, v2
v_lshl_or_b32 v96, v7, 24, v96
ds_add_rtn_u32 v126, v76, v1 offset:4096
v_mul_hi_u32_u24 v2, s80, v77
v_mul_hi_u32_u24 v7, s88, v97
v_mad_i32_i24 v3, v2, s81, v77
v_mul_hi_u32_u24 v77, s89, v97
v_lshl_add_u32 v2, v2, 2, v7
v_mad_i32_i24 v97, v77, s93, v97
v_mad_i32_i24 v7, v7, s3, v77
v_lshl_or_b32 v97, v3, 9, v97
v_lshlrev_b32 v77, 2, v2
v_lshl_or_b32 v97, v7, 24, v97
ds_add_rtn_u32 v127, v77, v1 offset:4096
v_lshlrev_b32 v2, 16, v104
v_and_b32 v3, 0xffff0000, v104
v_mul_f32 v2, 0.15915494, v2
v_mul_f32 v3, 0.15915494, v3
v_fract_f32 v2, v2
v_fract_f32 v3, v3
v_cvt_pknorm_u16_f32 v104, v2, v3
v_lshlrev_b32 v2, 16, v104
v_and_or_b32 v91, v104, s87, v91
v_and_or_b32 v90, v2, s87, v90
v_lshrrev_b32 v104, 8, v104
v_lshlrev_b32 v2, 16, v105
v_and_b32 v3, 0xffff0000, v105
v_mul_f32 v2, 0.15915494, v2
v_mul_f32 v3, 0.15915494, v3
v_fract_f32 v2, v2
v_fract_f32 v3, v3
v_cvt_pknorm_u16_f32 v105, v2, v3
v_lshlrev_b32 v2, 16, v105
v_and_or_b32 v93, v105, s87, v93
v_and_or_b32 v92, v2, s87, v92
v_lshrrev_b32 v105, 8, v105
s_waitcnt vmcnt(0)
v_lshlrev_b32 v2, 16, v106
v_and_b32 v3, 0xffff0000, v106
v_mul_f32 v2, 0.15915494, v2
v_mul_f32 v3, 0.15915494, v3
v_fract_f32 v2, v2
v_fract_f32 v3, v3
v_cvt_pknorm_u16_f32 v106, v2, v3
v_lshlrev_b32 v2, 16, v106
v_and_or_b32 v95, v106, s87, v95
v_and_or_b32 v94, v2, s87, v94
v_lshrrev_b32 v106, 8, v106
v_lshlrev_b32 v2, 16, v107
v_and_b32 v3, 0xffff0000, v107
v_mul_f32 v2, 0.15915494, v2
v_mul_f32 v3, 0.15915494, v3
v_fract_f32 v2, v2
v_fract_f32 v3, v3
v_cvt_pknorm_u16_f32 v107, v2, v3
v_lshlrev_b32 v2, 16, v107
v_and_or_b32 v97, v107, s87, v97
v_and_or_b32 v96, v2, s87, v96
v_lshrrev_b32 v107, 8, v107
s_mov_b64 exec, -1
s_waitcnt vmcnt(0) lgkmcnt(0)
s_barrier
s_cmp_lg_u32 s90, 0
s_cbranch_scc1 L_scan_skip_4
buffer_store_dwordx4 v[8:11], v4, s[76:79], 0 offen
buffer_store_dwordx4 v[12:15], v4, s[76:79], s82 offen
buffer_store_dwordx4 v[16:19], v4, s[76:79], s83 offen
buffer_store_dwordx4 v[20:23], v4, s[76:79], s84 offen
buffer_store_dwordx4 v[24:27], v4, s[76:79], s85 offen
buffer_store_dwordx4 v[28:31], v4, s[76:79], s86 offen
v_add_u32 v2, 98304, v4
buffer_store_dwordx4 v[32:35], v2, s[76:79], 0 offen
s_mov_b32 s78, 0
s_nop 1
v_lshlrev_b32 v40, 6, v0
ds_read_b128 v[8:11], v40 offset:4096
ds_read_b128 v[12:15], v40 offset:4112
ds_read_b128 v[16:19], v40 offset:4128
ds_read_b128 v[20:23], v40 offset:4144
s_waitcnt lgkmcnt(0)
v_mov_b32 v24, 0
v_add_u32 v25, v24, v8
v_add_u32 v26, v25, v9
v_add_u32 v27, v26, v10
v_add_u32 v28, v27, v11
v_add_u32 v29, v28, v12
v_add_u32 v30, v29, v13
v_add_u32 v31, v30, v14
v_add_u32 v32, v31, v15
v_add_u32 v33, v32, v16
v_add_u32 v34, v33, v17
v_add_u32 v35, v34, v18
v_add_u32 v36, v35, v19
v_add_u32 v37, v36, v20
v_add_u32 v38, v37, v21
v_add_u32 v39, v38, v22
v_add_u32 v41, v39, v23
v_mov_b32 v42, v41
s_nop 1
v_add_u32_dpp v41, v41, v41 row_shr:1 row_mask:0xf bank_mask:0xf bound_ctrl:0
s_nop 1
v_add_u32_dpp v41, v41, v41 row_shr:2 row_mask:0xf bank_mask:0xf bound_ctrl:0
s_nop 1
v_add_u32_dpp v41, v41, v41 row_shr:4 row_mask:0xf bank_mask:0xf bound_ctrl:0
s_nop 1
v_add_u32_dpp v41, v41, v41 row_shr:8 row_mask:0xf bank_mask:0xf bound_ctrl:0
s_nop 1
v_add_u32_dpp v41, v41, v41 row_bcast:15 row_mask:0xa bank_mask:0xf
s_nop 1
v_add_u32_dpp v41, v41, v41 row_bcast:31 row_mask:0xc bank_mask:0xf
v_sub_u32 v41, v41, v42
v_add_u32 v24, v24, v41
v_lshl_or_b32 v8, v8, 16, v24
v_add_u32 v25, v25, v41
v_lshl_or_b32 v9, v9, 16, v25
v_add_u32 v26, v26, v41
v_lshl_or_b32 v10, v10, 16, v26
v_add_u32 v27, v27, v41
v_lshl_or_b32 v11, v11, 16, v27
v_add_u32 v28, v28, v41
v_lshl_or_b32 v12, v12, 16, v28
v_add_u32 v29, v29, v41
v_lshl_or_b32 v13, v13, 16, v29
v_add_u32 v30, v30, v41
v_lshl_or_b32 v14, v14, 16, v30
v_add_u32 v31, v31, v41
v_lshl_or_b32 v15, v15, 16, v31
v_add_u32 v32, v32, v41
v_lshl_or_b32 v16, v16, 16, v32
v_add_u32 v33, v33, v41
v_lshl_or_b32 v17, v17, 16, v33
v_add_u32 v34, v34, v41
v_lshl_or_b32 v18, v18, 16, v34
v_add_u32 v35, v35, v41
v_lshl_or_b32 v19, v19, 16, v35
v_add_u32 v36, v36, v41
v_lshl_or_b32 v20, v20, 16, v36
v_add_u32 v37, v37, v41
v_lshl_or_b32 v21, v21, 16, v37
v_add_u32 v38, v38, v41
v_lshl_or_b32 v22, v22, 16, v38
v_add_u32 v39, v39, v41
v_lshl_or_b32 v23, v23, 16, v39
s_lshl_b32 s92, s91, 12
buffer_store_dwordx4 v[8:11], v40, s[72:75], s92 offen offset:0
ds_write_b128 v40, v[24:27] offset:4096
buffer_store_dwordx4 v[12:15], v40, s[72:75], s92 offen offset:16
ds_write_b128 v40, v[28:31] offset:4112
buffer_store_dwordx4 v[16:19], v40, s[72:75], s92 offen offset:32
ds_write_b128 v40, v[32:35] offset:4128
buffer_store_dwordx4 v[20:23], v40, s[72:75], s92 offen offset:48
ds_write_b128 v40, v[36:39] offset:4144
s_waitcnt lgkmcnt(0)
L_scan_skip_4:
s_barrier
s_mov_b64 exec, s[94:95]
ds_read_b32 v58, v58 offset:4096
ds_read_b32 v59, v59 offset:4096
ds_read_b32 v60, v60 offset:4096
ds_read_b32 v61, v61 offset:4096
ds_read_b32 v62, v62 offset:4096
ds_read_b32 v63, v63 offset:4096
ds_read_b32 v64, v64 offset:4096
ds_read_b32 v65, v65 offset:4096
s_waitcnt lgkmcnt(4)
v_add_u32 v58, v58, v108
v_lshrrev_b32 v2, 2, v58
v_add_lshl_u32 v3, v58, v2, 2
v_lshl_add_u32 v2, v2, 4, v58
ds_write_b32 v3, v78 offset:8256
ds_write_b8 v2, v98 offset:8272
v_add_u32 v59, v59, v109
v_lshrrev_b32 v2, 2, v59
v_add_lshl_u32 v3, v59, v2, 2
v_lshl_add_u32 v2, v2, 4, v59
ds_write_b32 v3, v79 offset:8256
ds_write_b8_d16_hi v2, v98 offset:8272
s_mov_b64 exec, -1
buffer_store_dwordx4 v[8:11], v4, s[76:79], 0 offen
s_mov_b64 exec, s[94:95]
v_add_u32 v60, v60, v110
v_lshrrev_b32 v2, 2, v60
v_add_lshl_u32 v3, v60, v2, 2
v_lshl_add_u32 v2, v2, 4, v60
ds_write_b32 v3, v80 offset:8256
ds_write_b8 v2, v99 offset:8272
v_add_u32 v61, v61, v111
v_lshrrev_b32 v2, 2, v61
v_add_lshl_u32 v3, v61, v2, 2
v_lshl_add_u32 v2, v2, 4, v61
ds_write_b32 v3, v81 offset:8256
ds_write_b8_d16_hi v2, v99 offset:8272
s_mov_b64 exec, -1
buffer_store_dwordx4 v[12:15], v4, s[76:79], s82 offen
s_mov_b64 exec, s[94:95]
s_waitcnt lgkmcnt(8)
ds_read_b32 v66, v66 offset:4096
ds_read_b32 v67, v67 offset:4096
ds_read_b32 v68, v68 offset:4096
ds_read_b32 v69, v69 offset:4096
s_waitcnt lgkmcnt(4)
v_add_u32 v62, v62, v112
v_lshrrev_b32 v2, 2, v62
v_add_lshl_u32 v3, v62, v2, 2
v_lshl_add_u32 v2, v2, 4, v62
ds_write_b32 v3, v82 offset:8256
ds_write_b8 v2, v100 offset:8272
v_add_u32 v63, v63, v113
v_lshrrev_b32 v2, 2, v63
v_add_lshl_u32 v3, v63, v2, 2
v_lshl_add_u32 v2, v2, 4, v63
ds_write_b32 v3, v83 offset:8256
ds_write_b8_d16_hi v2, v100 offset:8272
s_mov_b64 exec, -1
buffer_store_dwordx4 v[16:19], v4, s[76:79], s83 offen
s_mov_b64 exec, s[94:95]
v_add_u32 v64, v64, v114
v_lshrrev_b32 v2, 2, v64
v_add_lshl_u32 v3, v64, v2, 2
v_lshl_add_u32 v2, v2, 4, v64
ds_write_b32 v3, v84 offset:8256
ds_write_b8 v2, v101 offset:8272
v_add_u32 v65, v65, v115
v_lshrrev_b32 v2, 2, v65
v_add_lshl_u32 v3, v65, v2, 2
v_lshl_add_u32 v2, v2, 4, v65
ds_write_b32 v3, v85 offset:8256
ds_write_b8_d16_hi v2, v101 offset:8272
s_mov_b64 exec, -1
buffer_store_dwordx4 v[20:23], v4, s[76:79], s84 offen
s_mov_b64 exec, s[94:95]
s_waitcnt lgkmcnt(8)
ds_read_b32 v70, v70 offset:4096
ds_read_b32 v71, v71 offset:4096
ds_read_b32 v72, v72 offset:4096
ds_read_b32 v73, v73 offset:4096
s_waitcnt lgkmcnt(4)
v_add_u32 v66, v66, v116
v_lshrrev_b32 v2, 2, v66
v_add_lshl_u32 v3, v66, v2, 2
v_lshl_add_u32 v2, v2, 4, v66
ds_write_b32 v3, v86 offset:8256
ds_write_b8 v2, v102 offset:8272
v_add_u32 v67, v67, v117
v_lshrrev_b32 v2, 2, v67
v_add_lshl_u32 v3, v67, v2, 2
v_lshl_add_u32 v2, v2, 4, v67
ds_write_b32 v3, v87 offset:8256
ds_write_b8_d16_hi v2, v102 offset:8272
s_mov_b64 exec, -1
buffer_store_dwordx4 v[24:27], v4, s[76:79], s85 offen
s_mov_b64 exec, s[94:95]
v_add_u32 v68, v68, v118
v_lshrrev_b32 v2, 2, v68
v_add_lshl_u32 v3, v68, v2, 2
v_lshl_add_u32 v2, v2, 4, v68
ds_write_b32 v3, v88 offset:8256
ds_write_b8 v2, v103 offset:8272
v_add_u32 v69, v69, v119
v_lshrrev_b32 v2, 2, v69
v_add_lshl_u32 v3, v69, v2, 2
v_lshl_add_u32 v2, v2, 4, v69
ds_write_b32 v3, v89 offset:8256
ds_write_b8_d16_hi v2, v103 offset:8272
s_mov_b64 exec, -1
buffer_store_dwordx4 v[28:31], v4, s[76:79], s86 offen
s_mov_b64 exec, s[94:95]
s_waitcnt lgkmcnt(8)
ds_read_b32 v74, v74 offset:4096
ds_read_b32 v75, v75 offset:4096
ds_read_b32 v76, v76 offset:4096
ds_read_b32 v77, v77 offset:4096
s_waitcnt lgkmcnt(4)
v_add_u32 v70, v70, v120
v_lshrrev_b32 v2, 2, v70
v_add_lshl_u32 v3, v70, v2, 2
v_lshl_add_u32 v2, v2, 4, v70
ds_write_b32 v3, v90 offset:8256
ds_write_b8 v2, v104 offset:8272
v_add_u32 v71, v71, v121
v_lshrrev_b32 v2, 2, v71
v_add_lshl_u32 v3, v71, v2, 2
v_lshl_add_u32 v2, v2, 4, v71
ds_write_b32 v3, v91 offset:8256
ds_write_b8_d16_hi v2, v104 offset:8272
s_mov_b64 exec, -1
v_add_u32 v2, 98304, v4
buffer_store_dwordx4 v[32:35], v2, s[76:79], 0 offen
s_mov_b64 exec, s[94:95]
v_add_u32 v72, v72, v122
v_lshrrev_b32 v2, 2, v72
v_add_lshl_u32 v3, v72, v2, 2
v_lshl_add_u32 v2, v2, 4, v72
ds_write_b32 v3, v92 offset:8256
ds_write_b8 v2, v105 offset:8272
v_add_u32 v73, v73, v123
v_lshrrev_b32 v2, 2, v73
v_add_lshl_u32 v3, v73, v2, 2
v_lshl_add_u32 v2, v2, 4, v73
ds_write_b32 v3, v93 offset:8256
ds_write_b8_d16_hi v2, v105 offset:8272
s_waitcnt lgkmcnt(0)
v_add_u32 v74, v74, v124
v_lshrrev_b32 v2, 2, v74
v_add_lshl_u32 v3, v74, v2, 2
v_lshl_add_u32 v2, v2, 4, v74
ds_write_b32 v3, v94 offset:8256
ds_write_b8 v2, v106 offset:8272
v_add_u32 v75, v75, v125
v_lshrrev_b32 v2, 2, v75
v_add_lshl_u32 v3, v75, v2, 2
v_lshl_add_u32 v2, v2, 4, v75
ds_write_b32 v3, v95 offset:8256
ds_write_b8_d16_hi v2, v106 offset:8272
v_add_u32 v76, v76, v126
v_lshrrev_b32 v2, 2, v76
v_add_lshl_u32 v3, v76, v2, 2
v_lshl_add_u32 v2, v2, 4, v76
ds_write_b32 v3, v96 offset:8256
ds_write_b8 v2, v107 offset:8272
v_add_u32 v77, v77, v127
v_lshrrev_b32 v2, 2, v77
v_add_lshl_u32 v3, v77, v2, 2
v_lshl_add_u32 v2, v2, 4, v77
ds_write_b32 v3, v97 offset:8256
ds_write_b8_d16_hi v2, v107 offset:8272
s_mov_b64 exec, -1
s_waitcnt lgkmcnt(0)
s_barrier
s_mul_i32 s92, s91, 100000
s_add_u32 s92, s92, 5242880
s_add_u32 s76, s14, s92
s_addc_u32 s77, s15, 0
s_and_b32 s77, s77, 0xffff
s_mov_b32 s78, 100000
s_mov_b32 s79, 0x20000
ds_read_b128 v[108:111], v4 offset:8256
ds_read_b128 v[112:115], v4 offset:24640
ds_read_b128 v[116:119], v4 offset:41024
ds_read_b128 v[120:123], v4 offset:57408
ds_read_b128 v[124:127], v6 offset:8256
ds_read_b128 v[58:61], v6 offset:24640
ds_read_b128 v[62:65], v6 offset:41024
s_waitcnt lgkmcnt(6)
buffer_store_dwordx4 v[108:111], v4, s[76:79], 0 offen
s_waitcnt lgkmcnt(5)
buffer_store_dwordx4 v[112:115], v4, s[76:79], s82 offen
s_waitcnt lgkmcnt(4)
buffer_store_dwordx4 v[116:119], v4, s[76:79], s83 offen
s_waitcnt lgkmcnt(3)
buffer_store_dwordx4 v[120:123], v4, s[76:79], s84 offen
s_waitcnt lgkmcnt(2)
buffer_store_dwordx4 v[124:127], v4, s[76:79], s85 offen
s_waitcnt lgkmcnt(1)
buffer_store_dwordx4 v[58:61], v4, s[76:79], s86 offen
s_waitcnt lgkmcnt(0)
v_add_u32 v2, 98304, v4
buffer_store_dwordx4 v[62:65], v2, s[76:79], 0 offen
L_k1_end:
s_endpgm
.globl gather_scatter__molecular_angular_gemnet__graph_kernel
.p2align 8
.type gather_scatter__molecular_angular_gemnet__graph_kernel,@function
gather_scatter__molecular_angular_gemnet__graph_kernel:
s_cmp_ge_u32 s2, 256
s_cbranch_scc1 L_k2_end
s_getpc_b64 s[20:21]
L_cpf_5:
v_lshlrev_b32 v2, 7, v0
v_cmp_gt_u32 vcc, (L_k2_end-L_cpf_5), v2
s_and_saveexec_b64 s[22:23], vcc
global_load_dword v9, v2, s[20:21]
s_mov_b64 exec, s[22:23]
s_load_dwordx2 s[4:5], s[0:1], 0
s_load_dwordx2 s[6:7], s[0:1], 24
s_load_dwordx2 s[8:9], s[0:1], 40
s_load_dwordx4 s[12:15], s[0:1], 56
s_load_dwordx4 s[16:19], s[0:1], 80
s_load_dwordx2 s[10:11], s[0:1], 104
v_lshrrev_b32 v2, 6, v0
v_mov_b32 v4, 0
v_mov_b32 v5, 0
v_mov_b32 v6, 0
v_mov_b32 v7, 0
v_readfirstlane_b32 s3, v2
v_mov_b32 v1, 1
v_lshlrev_b32 v3, 4, v0
ds_write_b128 v3, v[4:7] offset:0
v_cmp_gt_u32 vcc, 229, v0
s_and_saveexec_b64 s[96:97], vcc
ds_write_b128 v3, v[4:7] offset:16384
s_mov_b64 exec, s[96:97]
v_cmp_gt_u32 vcc, 112, v0
s_and_saveexec_b64 s[96:97], vcc
ds_write_b128 v3, v[4:7] offset:50048
s_mov_b64 exec, s[96:97]
v_and_b32 v18, 63, v0
v_lshlrev_b32 v23, 2, v0
v_add_u32 v20, 64128, v23
v_lshrrev_b32 v19, 6, v0
v_lshlrev_b32 v19, 2, v19
v_lshl_add_u32 v26, v18, 6, v19
v_and_b32 v22, 1, v0
v_mov_b32 v24, 0x4b400000
v_mov_b32 v25, 0
s_waitcnt lgkmcnt(0)
s_add_u32 s20, s10, 5242880
s_addc_u32 s21, s11, 0
s_and_b32 s21, s21, 0xffff
s_mov_b32 s22, 51200000
s_mov_b32 s23, 0x20000
s_mov_b32 s24, s10
s_and_b32 s25, s11, 0xffff
s_mov_b32 s26, 320000
s_mov_b32 s27, 0x20000
s_or_b32 s25, s25, 524288
s_add_u32 s28, s10, 2621440
s_addc_u32 s29, s11, 0
s_and_b32 s29, s29, 0xffff
s_mov_b32 s30, 2097152
s_mov_b32 s31, 0x20000
s_add_u32 s32, s10, 4718592
s_addc_u32 s33, s11, 0
s_and_b32 s33, s33, 0xffff
s_mov_b32 s34, 4096
s_mov_b32 s35, 0x20000
v_lshrrev_b32 v2, 1, v0
v_lshlrev_b32 v2, 12, v2
s_lshl_b32 s101, s2, 4
v_add_u32 v2, s101, v2
buffer_load_dwordx4 v[10:13], v2, s[28:31], 0 offen
v_lshlrev_b32 v2, 4, v0
buffer_load_dwordx4 v[106:109], v2, s[32:35], 0 offen
s_mov_b32 s28, s6
s_and_b32 s29, s7, 0xffff
s_mov_b32 s30, 640000
s_mov_b32 s31, 0x20000
s_mul_i32 s101, s2, 1250
v_add_u32 v3, s101, v0
v_lshlrev_b32 v3, 1, v3
v_add_u32 v4, 2048, v3
v_mov_b32 v126, 0
v_mov_b32 v127, 0
buffer_load_short_d16_hi v126, v3, s[28:31], 0 offen
buffer_load_short_d16_hi v127, v4, s[28:31], 0 offen
s_load_dwordx4 s[36:39], s[8:9], 0
s_load_dwordx16 s[40:55], s[14:15], 0
s_load_dwordx16 s[56:71], s[14:15], 64
s_load_dwordx16 s[72:87], s[14:15], 128
s_mov_b32 s91, 0xffff0000
s_mov_b32 s94, s12
s_mov_b32 s95, s13
s_barrier
s_waitcnt vmcnt(3)
v_lshrrev_b32 v2, 1, v0
v_mul_u32_u24 v2, 20000, v2
v_and_b32 v3, 0xffff, v10
v_lshrrev_b32 v4, 16, v10
v_add_u32 v3, v2, v3
v_add_u32 v5, v3, v4
v_add_u32 v5, 3, v5
v_cmp_eq_u32 vcc, 0, v4
v_lshrrev_b32 v5, 2, v5
v_lshrrev_b32 v3, 2, v3
v_sub_u32 v5, v5, v3
v_cndmask_b32_e64 v110, v5, 0, vcc
v_and_b32 v3, 0xffff, v11
v_lshrrev_b32 v4, 16, v11
v_add_u32 v3, v2, v3
v_add_u32 v5, v3, v4
v_add_u32 v5, 3, v5
v_cmp_eq_u32 vcc, 0, v4
v_lshrrev_b32 v5, 2, v5
v_lshrrev_b32 v3, 2, v3
v_sub_u32 v5, v5, v3
v_cndmask_b32_e64 v111, v5, 0, vcc
v_and_b32 v3, 0xffff, v12
v_lshrrev_b32 v4, 16, v12
v_add_u32 v3, v2, v3
v_add_u32 v5, v3, v4
v_add_u32 v5, 3, v5
v_cmp_eq_u32 vcc, 0, v4
v_lshrrev_b32 v5, 2, v5
v_lshrrev_b32 v3, 2, v3
v_sub_u32 v5, v5, v3
v_cndmask_b32_e64 v112, v5, 0, vcc
v_and_b32 v3, 0xffff, v13
v_lshrrev_b32 v4, 16, v13
v_add_u32 v3, v2, v3
v_add_u32 v5, v3, v4
v_add_u32 v5, 3, v5
v_cmp_eq_u32 vcc, 0, v4
v_lshrrev_b32 v5, 2, v5
v_lshrrev_b32 v3, 2, v3
v_sub_u32 v5, v5, v3
v_cndmask_b32_e64 v113, v5, 0, vcc
v_cmp_eq_u32 vcc, 0, v22
s_nop 1
v_cndmask_b32_e64 v114, 0, v110, vcc
v_cndmask_b32_e64 v115, 0, v111, vcc
v_cndmask_b32_e64 v116, 0, v112, vcc
v_cndmask_b32_e64 v117, 0, v113, vcc
s_nop 0
v_add_u32_dpp v114, v114, v114 row_shr:1 row_mask:0xf bank_mask:0xf bound_ctrl:0
v_add_u32_dpp v115, v115, v115 row_shr:1 row_mask:0xf bank_mask:0xf bound_ctrl:0
v_add_u32_dpp v116, v116, v116 row_shr:1 row_mask:0xf bank_mask:0xf bound_ctrl:0
v_add_u32_dpp v117, v117, v117 row_shr:1 row_mask:0xf bank_mask:0xf bound_ctrl:0
s_nop 0
v_add_u32_dpp v114, v114, v114 row_shr:2 row_mask:0xf bank_mask:0xf bound_ctrl:0
v_add_u32_dpp v115, v115, v115 row_shr:2 row_mask:0xf bank_mask:0xf bound_ctrl:0
v_add_u32_dpp v116, v116, v116 row_shr:2 row_mask:0xf bank_mask:0xf bound_ctrl:0
v_add_u32_dpp v117, v117, v117 row_shr:2 row_mask:0xf bank_mask:0xf bound_ctrl:0
s_nop 0
v_add_u32_dpp v114, v114, v114 row_shr:4 row_mask:0xf bank_mask:0xf bound_ctrl:0
v_add_u32_dpp v115, v115, v115 row_shr:4 row_mask:0xf bank_mask:0xf bound_ctrl:0
v_add_u32_dpp v116, v116, v116 row_shr:4 row_mask:0xf bank_mask:0xf bound_ctrl:0
v_add_u32_dpp v117, v117, v117 row_shr:4 row_mask:0xf bank_mask:0xf bound_ctrl:0
s_nop 0
v_add_u32_dpp v114, v114, v114 row_shr:8 row_mask:0xf bank_mask:0xf bound_ctrl:0
v_add_u32_dpp v115, v115, v115 row_shr:8 row_mask:0xf bank_mask:0xf bound_ctrl:0
v_add_u32_dpp v116, v116, v116 row_shr:8 row_mask:0xf bank_mask:0xf bound_ctrl:0
v_add_u32_dpp v117, v117, v117 row_shr:8 row_mask:0xf bank_mask:0xf bound_ctrl:0
s_nop 0
v_add_u32_dpp v114, v114, v114 row_bcast:15 row_mask:0xa bank_mask:0xf
v_add_u32_dpp v115, v115, v115 row_bcast:15 row_mask:0xa bank_mask:0xf
v_add_u32_dpp v116, v116, v116 row_bcast:15 row_mask:0xa bank_mask:0xf
v_add_u32_dpp v117, v117, v117 row_bcast:15 row_mask:0xa bank_mask:0xf
s_nop 0
v_add_u32_dpp v114, v114, v114 row_bcast:31 row_mask:0xc bank_mask:0xf
v_add_u32_dpp v115, v115, v115 row_bcast:31 row_mask:0xc bank_mask:0xf
v_add_u32_dpp v116, v116, v116 row_bcast:31 row_mask:0xc bank_mask:0xf
v_add_u32_dpp v117, v117, v117 row_bcast:31 row_mask:0xc bank_mask:0xf
v_cmp_eq_u32 vcc, 63, v18
s_and_saveexec_b64 s[96:97], vcc
ds_add_rtn_u32 v4, v25, v114 offset:20016
ds_add_rtn_u32 v5, v25, v115 offset:20020
ds_add_rtn_u32 v6, v25, v116 offset:20024
ds_add_rtn_u32 v7, v25, v117 offset:20028
s_mov_b64 exec, s[96:97]
s_waitcnt vmcnt(2)
s_nop 0
v_max_u32_dpp v106, v106, v106 row_shr:1 row_mask:0xf bank_mask:0xf bound_ctrl:0
v_max_u32_dpp v107, v107, v107 row_shr:1 row_mask:0xf bank_mask:0xf bound_ctrl:0
v_max_u32_dpp v108, v108, v108 row_shr:1 row_mask:0xf bank_mask:0xf bound_ctrl:0
v_max_u32_dpp v109, v109, v109 row_shr:1 row_mask:0xf bank_mask:0xf bound_ctrl:0
s_nop 0
v_max_u32_dpp v106, v106, v106 row_shr:2 row_mask:0xf bank_mask:0xf bound_ctrl:0
v_max_u32_dpp v107, v107, v107 row_shr:2 row_mask:0xf bank_mask:0xf bound_ctrl:0
v_max_u32_dpp v108, v108, v108 row_shr:2 row_mask:0xf bank_mask:0xf bound_ctrl:0
v_max_u32_dpp v109, v109, v109 row_shr:2 row_mask:0xf bank_mask:0xf bound_ctrl:0
s_nop 0
v_max_u32_dpp v106, v106, v106 row_shr:4 row_mask:0xf bank_mask:0xf bound_ctrl:0
v_max_u32_dpp v107, v107, v107 row_shr:4 row_mask:0xf bank_mask:0xf bound_ctrl:0
v_max_u32_dpp v108, v108, v108 row_shr:4 row_mask:0xf bank_mask:0xf bound_ctrl:0
v_max_u32_dpp v109, v109, v109 row_shr:4 row_mask:0xf bank_mask:0xf bound_ctrl:0
s_nop 0
v_max_u32_dpp v106, v106, v106 row_shr:8 row_mask:0xf bank_mask:0xf bound_ctrl:0
v_max_u32_dpp v107, v107, v107 row_shr:8 row_mask:0xf bank_mask:0xf bound_ctrl:0
v_max_u32_dpp v108, v108, v108 row_shr:8 row_mask:0xf bank_mask:0xf bound_ctrl:0
v_max_u32_dpp v109, v109, v109 row_shr:8 row_mask:0xf bank_mask:0xf bound_ctrl:0
s_nop 0
v_max_u32_dpp v106, v106, v106 row_bcast:15 row_mask:0xa bank_mask:0xf
v_max_u32_dpp v107, v107, v107 row_bcast:15 row_mask:0xa bank_mask:0xf
v_max_u32_dpp v108, v108, v108 row_bcast:15 row_mask:0xa bank_mask:0xf
v_max_u32_dpp v109, v109, v109 row_bcast:15 row_mask:0xa bank_mask:0xf
s_nop 0
v_max_u32_dpp v106, v106, v106 row_bcast:31 row_mask:0xc bank_mask:0xf
v_max_u32_dpp v107, v107, v107 row_bcast:31 row_mask:0xc bank_mask:0xf
v_max_u32_dpp v108, v108, v108 row_bcast:31 row_mask:0xc bank_mask:0xf
v_max_u32_dpp v109, v109, v109 row_bcast:31 row_mask:0xc bank_mask:0xf
v_cmp_eq_u32 vcc, 63, v18
s_and_saveexec_b64 s[96:97], vcc
ds_max_u32 v25, v106 offset:20000
ds_max_u32 v25, v107 offset:20004
ds_max_u32 v25, v108 offset:20008
ds_max_u32 v25, v109 offset:20012
s_mov_b64 exec, s[96:97]
s_waitcnt lgkmcnt(0)
v_readlane_b32 s101, v4, 63
v_sub_u32 v14, v114, v110
s_nop 0
v_add_u32 v14, s101, v14
v_readlane_b32 s101, v5, 63
v_sub_u32 v15, v115, v111
s_nop 0
v_add_u32 v15, s101, v15
v_readlane_b32 s101, v6, 63
v_sub_u32 v16, v116, v112
s_nop 0
v_add_u32 v16, s101, v16
v_readlane_b32 s101, v7, 63
v_sub_u32 v17, v117, v113
s_nop 0
v_add_u32 v17, s101, v17
s_mov_b32 s30, 3072
s_mov_b32 s28, 64128
s_mov_b32 s88, 0x7ff800
s_mov_b32 s6, 0
s_mov_b32 s7, 0
s_mov_b32 s12, 51840
v_mov_b32 v2, v10
v_mov_b32 v3, v14
v_lshrrev_b32 v5, 1, v0
v_mul_u32_u24 v5, 20000, v5
v_and_b32 v4, 0xffff, v2
v_add_u32 v4, v4, v5
v_lshrrev_b32 v2, 16, v2
v_add_u32 v5, v4, v2
v_add_u32 v6, 3, v5
v_cmp_eq_u32 vcc, 0, v2
v_lshrrev_b32 v6, 2, v6
v_lshrrev_b32 v7, 2, v4
v_sub_u32 v6, v6, v7
v_sub_u32 v8, s7, v3
v_cndmask_b32_e64 v6, v6, 0, vcc
v_max_i32 v8, 0, v8
v_xor_b32 v2, v8, v22
v_and_b32 v2, 1, v2
v_add_u32 v8, v8, v2
v_subrev_u32 v3, s7, v3
s_mov_b64 s[96:97], exec
L_build_6:
v_add_u32 v2, v3, v8
v_cmp_lt_u32 vcc, v8, v6
v_cmp_gt_u32 s[98:99], s30, v2
s_and_b64 vcc, vcc, s[98:99]
s_and_b64 exec, exec, vcc
s_cbranch_execz L_build_restore_8
v_add_u32 v9, v7, v8
v_lshlrev_b32 v120, 2, v9
v_max_u32 v121, v120, v4
v_sub_u32 v121, v121, v120
v_sub_u32 v120, v5, v120
v_min_u32 v120, 4, v120
v_sub_u32 v120, v120, v121
v_bfm_b32 v120, v120, v121
v_lshl_or_b32 v9, v9, 4, v120
v_lshl_add_u32 v2, v2, 2, s12
ds_write_b32 v2, v9
v_add_u32 v8, 2, v8
s_branch L_build_6
L_build_restore_8:
s_mov_b64 exec, s[96:97]
L_build_done_7:
s_waitcnt vmcnt(0) lgkmcnt(0)
s_barrier
ds_read_b128 v[4:7], v25 offset:20016
ds_read_b128 v[106:109], v25 offset:20000
s_waitcnt lgkmcnt(0)
v_readfirstlane_b32 s32, v4
v_readfirstlane_b32 s33, v5
v_readfirstlane_b32 s34, v6
v_readfirstlane_b32 s35, v7
s_nop 3
s_min_u32 s8, s32, 3072
s_mov_b32 s9, 0
s_mov_b32 s100, 50048
s_mov_b32 s89, s93
s_mov_b32 s92, s8
s_mov_b32 s93, s9
s_mov_b32 s13, s12
v_add_u32 v27, s13, v23
ds_read_b32 v60, v27 offset:0
ds_read_b32 v61, v27 offset:4096
ds_read_b32 v62, v27 offset:8192
s_waitcnt lgkmcnt(0)
s_sub_i32 s101, s92, 0
s_max_i32 s101, s101, 0
v_cmp_gt_u32 vcc, s101, v0
v_lshrrev_b32 v63, 4, v60
v_and_b32 v60, 15, v60
v_mul_u32_u24 v63, 20, v63
v_cndmask_b32_e64 v60, 0, v60, vcc
s_sub_i32 s101, s92, 1024
s_max_i32 s101, s101, 0
v_cmp_gt_u32 vcc, s101, v0
v_lshrrev_b32 v64, 4, v61
v_and_b32 v61, 15, v61
v_mul_u32_u24 v64, 20, v64
v_cndmask_b32_e64 v61, 0, v61, vcc
s_sub_i32 s101, s92, 2048
s_max_i32 s101, s101, 0
v_cmp_gt_u32 vcc, s101, v0
v_lshrrev_b32 v65, 4, v62
v_and_b32 v62, 15, v62
v_mul_u32_u24 v65, 20, v65
v_cndmask_b32_e64 v62, 0, v62, vcc
s_sub_i32 s101, s92, 0
s_max_i32 s101, s101, 0
v_cmp_gt_u32 vcc, s101, v0
s_nop 0
s_mov_b64 exec, vcc
buffer_load_dwordx4 v[42:45], v63, s[20:23], 0 offen
s_mov_b64 exec, -1
s_sub_i32 s101, s92, 0
s_max_i32 s101, s101, 0
v_cmp_gt_u32 vcc, s101, v0
s_nop 0
s_mov_b64 exec, vcc
buffer_load_dword v54, v63, s[20:23], 0 offen offset:16
s_mov_b64 exec, -1
s_add_u32 s7, s7, 3072
L_nb_loop_9:
s_cmp_ge_u32 s6, 4
s_cbranch_scc1 L_nb_end_11
s_mov_b32 s8, s32
s_mov_b32 s9, 0
s_cmp_eq_u32 s6, 1
s_cselect_b32 s8, s33, s8
s_cselect_b32 s9, 210, s9
s_cmp_eq_u32 s6, 2
s_cselect_b32 s8, s34, s8
s_cselect_b32 s9, 420, s9
s_cmp_eq_u32 s6, 3
s_cselect_b32 s8, s35, s8
s_cselect_b32 s9, 630, s9
s_cmp_lt_u32 s7, s8
s_cbranch_scc1 L_nb_done_10
s_add_u32 s6, s6, 1
s_mov_b32 s7, 0
s_branch L_nb_loop_9
L_nb_end_11:
s_mov_b32 s8, 0
s_mov_b32 s7, 0
L_nb_done_10:
s_sub_u32 s8, s8, s7
s_min_u32 s8, s8, 3072
s_xor_b32 s12, s12, 69632
s_cmp_eq_u32 s8, 0
s_cbranch_scc1 L_build_done_13
v_mov_b32 v2, v10
v_mov_b32 v3, v14
s_cmp_lg_u32 s6, 1
s_cbranch_scc1 L_bq_14
v_mov_b32 v2, v11
v_mov_b32 v3, v15
L_bq_14:
s_cmp_lg_u32 s6, 2
s_cbranch_scc1 L_bq_15
v_mov_b32 v2, v12
v_mov_b32 v3, v16
L_bq_15:
s_cmp_lg_u32 s6, 3
s_cbranch_scc1 L_bq_16
v_mov_b32 v2, v13
v_mov_b32 v3, v17
L_bq_16:
v_lshrrev_b32 v5, 1, v0
v_mul_u32_u24 v5, 20000, v5
v_and_b32 v4, 0xffff, v2
v_add_u32 v4, v4, v5
v_lshrrev_b32 v2, 16, v2
v_add_u32 v5, v4, v2
v_add_u32 v6, 3, v5
v_cmp_eq_u32 vcc, 0, v2
v_lshrrev_b32 v6, 2, v6
v_lshrrev_b32 v7, 2, v4
v_sub_u32 v6, v6, v7
v_sub_u32 v8, s7, v3
v_cndmask_b32_e64 v6, v6, 0, vcc
v_max_i32 v8, 0, v8
v_xor_b32 v2, v8, v22
v_and_b32 v2, 1, v2
v_add_u32 v8, v8, v2
v_subrev_u32 v3, s7, v3
s_mov_b64 s[96:97], exec
L_build_12:
v_add_u32 v2, v3, v8
v_cmp_lt_u32 vcc, v8, v6
v_cmp_gt_u32 s[98:99], s30, v2
s_and_b64 vcc, vcc, s[98:99]
s_and_b64 exec, exec, vcc
s_cbranch_execz L_build_restore_17
v_add_u32 v9, v7, v8
v_lshlrev_b32 v120, 2, v9
v_max_u32 v121, v120, v4
v_sub_u32 v121, v121, v120
v_sub_u32 v120, v5, v120
v_min_u32 v120, 4, v120
v_sub_u32 v120, v120, v121
v_bfm_b32 v120, v120, v121
v_lshl_or_b32 v9, v9, 4, v120
v_lshl_add_u32 v2, v2, 2, s12
ds_write_b32 v2, v9
v_add_u32 v8, 2, v8
s_branch L_build_12
L_build_restore_17:
s_mov_b64 exec, s[96:97]
L_build_done_13:
s_lshl_b32 s101, s36, 16
v_subrev_f32 v66, s101, v126
s_and_b32 s101, s36, s91
v_subrev_f32 v67, s101, v126
v_cvt_pk_bf16_f32 v116, v66, v67
v_lshlrev_b32 v66, 16, v116
v_and_b32 v67, s91, v116
v_mul_f32 v66, v66, v66
v_mul_f32 v67, v67, v67
v_cvt_pk_bf16_f32 v116, v66, v67
v_lshlrev_b32 v66, 16, v116
v_and_b32 v67, s91, v116
v_mul_f32 v66, 0xc1200000, v66
v_mul_f32 v67, 0xc1200000, v67
v_cvt_pk_bf16_f32 v116, v66, v67
v_lshlrev_b32 v66, 16, v116
v_and_b32 v67, s91, v116
v_mul_f32 v66, 0x3fb8aa3b, v66
v_mul_f32 v67, 0x3fb8aa3b, v67
v_exp_f32 v66, v66
v_exp_f32 v67, v67
s_nop 0
v_cvt_pk_bf16_f32 v116, v66, v67
v_lshlrev_b32 v66, 16, v116
v_and_b32 v67, s91, v116
s_lshl_b32 s101, s37, 16
v_subrev_f32 v68, s101, v126
s_and_b32 s101, s37, s91
v_subrev_f32 v69, s101, v126
v_cvt_pk_bf16_f32 v116, v68, v69
v_lshlrev_b32 v68, 16, v116
v_and_b32 v69, s91, v116
v_mul_f32 v68, v68, v68
v_mul_f32 v69, v69, v69
v_cvt_pk_bf16_f32 v116, v68, v69
v_lshlrev_b32 v68, 16, v116
v_and_b32 v69, s91, v116
v_mul_f32 v68, 0xc1200000, v68
v_mul_f32 v69, 0xc1200000, v69
v_cvt_pk_bf16_f32 v116, v68, v69
v_lshlrev_b32 v68, 16, v116
v_and_b32 v69, s91, v116
v_mul_f32 v68, 0x3fb8aa3b, v68
v_mul_f32 v69, 0x3fb8aa3b, v69
v_exp_f32 v68, v68
v_exp_f32 v69, v69
s_nop 0
v_cvt_pk_bf16_f32 v116, v68, v69
v_lshlrev_b32 v68, 16, v116
v_and_b32 v69, s91, v116
s_lshl_b32 s101, s38, 16
v_subrev_f32 v70, s101, v126
s_and_b32 s101, s38, s91
v_subrev_f32 v71, s101, v126
v_cvt_pk_bf16_f32 v116, v70, v71
v_lshlrev_b32 v70, 16, v116
v_and_b32 v71, s91, v116
v_mul_f32 v70, v70, v70
v_mul_f32 v71, v71, v71
v_cvt_pk_bf16_f32 v116, v70, v71
v_lshlrev_b32 v70, 16, v116
v_and_b32 v71, s91, v116
v_mul_f32 v70, 0xc1200000, v70
v_mul_f32 v71, 0xc1200000, v71
v_cvt_pk_bf16_f32 v116, v70, v71
v_lshlrev_b32 v70, 16, v116
v_and_b32 v71, s91, v116
v_mul_f32 v70, 0x3fb8aa3b, v70
v_mul_f32 v71, 0x3fb8aa3b, v71
v_exp_f32 v70, v70
v_exp_f32 v71, v71
s_nop 0
v_cvt_pk_bf16_f32 v116, v70, v71
v_lshlrev_b32 v70, 16, v116
v_and_b32 v71, s91, v116
s_lshl_b32 s101, s39, 16
v_subrev_f32 v72, s101, v126
s_and_b32 s101, s39, s91
v_subrev_f32 v73, s101, v126
v_cvt_pk_bf16_f32 v116, v72, v73
v_lshlrev_b32 v72, 16, v116
v_and_b32 v73, s91, v116
v_mul_f32 v72, v72, v72
v_mul_f32 v73, v73, v73
v_cvt_pk_bf16_f32 v116, v72, v73
v_lshlrev_b32 v72, 16, v116
v_and_b32 v73, s91, v116
v_mul_f32 v72, 0xc1200000, v72
v_mul_f32 v73, 0xc1200000, v73
v_cvt_pk_bf16_f32 v116, v72, v73
v_lshlrev_b32 v72, 16, v116
v_and_b32 v73, s91, v116
v_mul_f32 v72, 0x3fb8aa3b, v72
v_mul_f32 v73, 0x3fb8aa3b, v73
v_exp_f32 v72, v72
v_exp_f32 v73, v73
s_nop 0
v_cvt_pk_bf16_f32 v116, v72, v73
v_lshlrev_b32 v72, 16, v116
v_and_b32 v73, s91, v116
s_lshl_b32 s101, s40, 16
v_mul_f32 v82, s101, v66
s_and_b32 s101, s40, s91
v_mul_f32 v83, s101, v66
s_lshl_b32 s101, s41, 16
v_mul_f32 v84, s101, v66
s_and_b32 s101, s41, s91
v_mul_f32 v85, s101, v66
s_lshl_b32 s101, s42, 16
v_mul_f32 v86, s101, v66
s_and_b32 s101, s42, s91
v_mul_f32 v87, s101, v66
s_lshl_b32 s101, s43, 16
v_mul_f32 v88, s101, v66
s_and_b32 s101, s43, s91
v_mul_f32 v89, s101, v66
s_lshl_b32 s101, s44, 16
v_mul_f32 v90, s101, v66
s_and_b32 s101, s44, s91
v_mul_f32 v91, s101, v66
s_lshl_b32 s101, s45, 16
v_mul_f32 v92, s101, v66
s_and_b32 s101, s45, s91
v_mul_f32 v93, s101, v66
s_sub_i32 s101, s92, 1024
s_max_i32 s101, s101, 0
v_cmp_gt_u32 vcc, s101, v0
s_nop 0
s_mov_b64 exec, vcc
buffer_load_dwordx4 v[46:49], v64, s[20:23], 0 offen
s_mov_b64 exec, -1
s_lshl_b32 s101, s46, 16
v_fmac_f32 v82, s101, v67
s_and_b32 s101, s46, s91
v_fmac_f32 v83, s101, v67
s_lshl_b32 s101, s47, 16
v_fmac_f32 v84, s101, v67
s_and_b32 s101, s47, s91
v_fmac_f32 v85, s101, v67
s_lshl_b32 s101, s48, 16
v_fmac_f32 v86, s101, v67
s_and_b32 s101, s48, s91
v_fmac_f32 v87, s101, v67
s_lshl_b32 s101, s49, 16
v_fmac_f32 v88, s101, v67
s_and_b32 s101, s49, s91
v_fmac_f32 v89, s101, v67
s_lshl_b32 s101, s50, 16
v_fmac_f32 v90, s101, v67
s_and_b32 s101, s50, s91
v_fmac_f32 v91, s101, v67
s_lshl_b32 s101, s51, 16
v_fmac_f32 v92, s101, v67
s_and_b32 s101, s51, s91
v_fmac_f32 v93, s101, v67
s_lshl_b32 s101, s52, 16
v_fmac_f32 v82, s101, v68
s_and_b32 s101, s52, s91
v_fmac_f32 v83, s101, v68
s_lshl_b32 s101, s53, 16
v_fmac_f32 v84, s101, v68
s_and_b32 s101, s53, s91
v_fmac_f32 v85, s101, v68
s_lshl_b32 s101, s54, 16
v_fmac_f32 v86, s101, v68
s_and_b32 s101, s54, s91
v_fmac_f32 v87, s101, v68
s_lshl_b32 s101, s55, 16
v_fmac_f32 v88, s101, v68
s_and_b32 s101, s55, s91
v_fmac_f32 v89, s101, v68
s_lshl_b32 s101, s56, 16
v_fmac_f32 v90, s101, v68
s_and_b32 s101, s56, s91
v_fmac_f32 v91, s101, v68
s_lshl_b32 s101, s57, 16
v_fmac_f32 v92, s101, v68
s_and_b32 s101, s57, s91
v_fmac_f32 v93, s101, v68
s_sub_i32 s101, s92, 1024
s_max_i32 s101, s101, 0
v_cmp_gt_u32 vcc, s101, v0
s_nop 0
s_mov_b64 exec, vcc
buffer_load_dword v55, v64, s[20:23], 0 offen offset:16
s_mov_b64 exec, -1
s_lshl_b32 s101, s58, 16
v_fmac_f32 v82, s101, v69
s_and_b32 s101, s58, s91
v_fmac_f32 v83, s101, v69
s_lshl_b32 s101, s59, 16
v_fmac_f32 v84, s101, v69
s_and_b32 s101, s59, s91
v_fmac_f32 v85, s101, v69
s_lshl_b32 s101, s60, 16
v_fmac_f32 v86, s101, v69
s_and_b32 s101, s60, s91
v_fmac_f32 v87, s101, v69
s_lshl_b32 s101, s61, 16
v_fmac_f32 v88, s101, v69
s_and_b32 s101, s61, s91
v_fmac_f32 v89, s101, v69
s_lshl_b32 s101, s62, 16
v_fmac_f32 v90, s101, v69
s_and_b32 s101, s62, s91
v_fmac_f32 v91, s101, v69
s_lshl_b32 s101, s63, 16
v_fmac_f32 v92, s101, v69
s_and_b32 s101, s63, s91
v_fmac_f32 v93, s101, v69
s_lshl_b32 s101, s64, 16
v_fmac_f32 v82, s101, v70
s_and_b32 s101, s64, s91
v_fmac_f32 v83, s101, v70
s_lshl_b32 s101, s65, 16
v_fmac_f32 v84, s101, v70
s_and_b32 s101, s65, s91
v_fmac_f32 v85, s101, v70
s_lshl_b32 s101, s66, 16
v_fmac_f32 v86, s101, v70
s_and_b32 s101, s66, s91
v_fmac_f32 v87, s101, v70
s_lshl_b32 s101, s67, 16
v_fmac_f32 v88, s101, v70
s_and_b32 s101, s67, s91
v_fmac_f32 v89, s101, v70
s_lshl_b32 s101, s68, 16
v_fmac_f32 v90, s101, v70
s_and_b32 s101, s68, s91
v_fmac_f32 v91, s101, v70
s_lshl_b32 s101, s69, 16
v_fmac_f32 v92, s101, v70
s_and_b32 s101, s69, s91
v_fmac_f32 v93, s101, v70
s_sub_i32 s101, s92, 2048
s_max_i32 s101, s101, 0
v_cmp_gt_u32 vcc, s101, v0
s_nop 0
s_mov_b64 exec, vcc
buffer_load_dwordx4 v[50:53], v65, s[20:23], 0 offen
s_mov_b64 exec, -1
s_lshl_b32 s101, s70, 16
v_fmac_f32 v82, s101, v71
s_and_b32 s101, s70, s91
v_fmac_f32 v83, s101, v71
s_lshl_b32 s101, s71, 16
v_fmac_f32 v84, s101, v71
s_and_b32 s101, s71, s91
v_fmac_f32 v85, s101, v71
s_lshl_b32 s101, s72, 16
v_fmac_f32 v86, s101, v71
s_and_b32 s101, s72, s91
v_fmac_f32 v87, s101, v71
s_lshl_b32 s101, s73, 16
v_fmac_f32 v88, s101, v71
s_and_b32 s101, s73, s91
v_fmac_f32 v89, s101, v71
s_lshl_b32 s101, s74, 16
v_fmac_f32 v90, s101, v71
s_and_b32 s101, s74, s91
v_fmac_f32 v91, s101, v71
s_lshl_b32 s101, s75, 16
v_fmac_f32 v92, s101, v71
s_and_b32 s101, s75, s91
v_fmac_f32 v93, s101, v71
s_lshl_b32 s101, s76, 16
v_fmac_f32 v82, s101, v72
s_and_b32 s101, s76, s91
v_fmac_f32 v83, s101, v72
s_lshl_b32 s101, s77, 16
v_fmac_f32 v84, s101, v72
s_and_b32 s101, s77, s91
v_fmac_f32 v85, s101, v72
s_lshl_b32 s101, s78, 16
v_fmac_f32 v86, s101, v72
s_and_b32 s101, s78, s91
v_fmac_f32 v87, s101, v72
s_lshl_b32 s101, s79, 16
v_fmac_f32 v88, s101, v72
s_and_b32 s101, s79, s91
v_fmac_f32 v89, s101, v72
s_lshl_b32 s101, s80, 16
v_fmac_f32 v90, s101, v72
s_and_b32 s101, s80, s91
v_fmac_f32 v91, s101, v72
s_lshl_b32 s101, s81, 16
v_fmac_f32 v92, s101, v72
s_and_b32 s101, s81, s91
v_fmac_f32 v93, s101, v72
s_sub_i32 s101, s92, 2048
s_max_i32 s101, s101, 0
v_cmp_gt_u32 vcc, s101, v0
s_nop 0
s_mov_b64 exec, vcc
buffer_load_dword v56, v65, s[20:23], 0 offen offset:16
s_mov_b64 exec, -1
s_lshl_b32 s101, s82, 16
v_fmac_f32 v82, s101, v73
s_and_b32 s101, s82, s91
v_fmac_f32 v83, s101, v73
s_lshl_b32 s101, s83, 16
v_fmac_f32 v84, s101, v73
s_and_b32 s101, s83, s91
v_fmac_f32 v85, s101, v73
s_lshl_b32 s101, s84, 16
v_fmac_f32 v86, s101, v73
s_and_b32 s101, s84, s91
v_fmac_f32 v87, s101, v73
s_lshl_b32 s101, s85, 16
v_fmac_f32 v88, s101, v73
s_and_b32 s101, s85, s91
v_fmac_f32 v89, s101, v73
s_lshl_b32 s101, s86, 16
v_fmac_f32 v90, s101, v73
s_and_b32 s101, s86, s91
v_fmac_f32 v91, s101, v73
s_lshl_b32 s101, s87, 16
v_fmac_f32 v92, s101, v73
s_and_b32 s101, s87, s91
v_fmac_f32 v93, s101, v73
v_cvt_pk_bf16_f32 v116, v82, v83
v_lshlrev_b32 v82, 16, v116
v_and_b32 v83, s91, v116
v_cvt_pk_bf16_f32 v116, v84, v85
v_lshlrev_b32 v84, 16, v116
v_and_b32 v85, s91, v116
v_cvt_pk_bf16_f32 v116, v86, v87
v_lshlrev_b32 v86, 16, v116
v_and_b32 v87, s91, v116
v_cvt_pk_bf16_f32 v116, v88, v89
v_lshlrev_b32 v88, 16, v116
v_and_b32 v89, s91, v116
v_cvt_pk_bf16_f32 v116, v90, v91
v_lshlrev_b32 v90, 16, v116
v_and_b32 v91, s91, v116
v_cvt_pk_bf16_f32 v116, v92, v93
v_lshlrev_b32 v92, 16, v116
v_and_b32 v93, s91, v116
v_mov_b32 v40, 0
v_add_f32_e64 v117, |v82|, |v86|
v_add_f32_e64 v117, v117, |v90|
v_mul_f32 v117, v117, v106
v_rcp_f32 v117, v117
s_nop 0
v_mul_f32 v117, 0x47048e80, v117
v_and_b32 v117, 0x7f800000, v117
v_min_f32 v117, 0x71800000, v117
v_max_f32 v117, 0x01000000, v117
v_mul_f32 v82, v117, v82
v_mul_f32 v86, v117, v86
v_mul_f32 v90, v117, v90
v_lshrrev_b32 v117, 23, v117
v_lshl_or_b32 v40, v117, 0, v40
v_add_f32_e64 v117, |v83|, |v87|
v_add_f32_e64 v117, v117, |v91|
v_mul_f32 v117, v117, v107
v_rcp_f32 v117, v117
s_nop 0
v_mul_f32 v117, 0x47048e80, v117
v_and_b32 v117, 0x7f800000, v117
v_min_f32 v117, 0x71800000, v117
v_max_f32 v117, 0x01000000, v117
v_mul_f32 v83, v117, v83
v_mul_f32 v87, v117, v87
v_mul_f32 v91, v117, v91
v_lshrrev_b32 v117, 23, v117
v_lshl_or_b32 v40, v117, 8, v40
v_add_f32_e64 v117, |v84|, |v88|
v_add_f32_e64 v117, v117, |v92|
v_mul_f32 v117, v117, v108
v_rcp_f32 v117, v117
s_nop 0
v_mul_f32 v117, 0x47048e80, v117
v_and_b32 v117, 0x7f800000, v117
v_min_f32 v117, 0x71800000, v117
v_max_f32 v117, 0x01000000, v117
v_mul_f32 v84, v117, v84
v_mul_f32 v88, v117, v88
v_mul_f32 v92, v117, v92
v_lshrrev_b32 v117, 23, v117
v_lshl_or_b32 v40, v117, 16, v40
v_add_f32_e64 v117, |v85|, |v89|
v_add_f32_e64 v117, v117, |v93|
v_mul_f32 v117, v117, v109
v_rcp_f32 v117, v117
s_nop 0
v_mul_f32 v117, 0x47048e80, v117
v_and_b32 v117, 0x7f800000, v117
v_min_f32 v117, 0x71800000, v117
v_max_f32 v117, 0x01000000, v117
v_mul_f32 v85, v117, v85
v_mul_f32 v89, v117, v89
v_mul_f32 v93, v117, v93
v_lshrrev_b32 v117, 23, v117
v_lshl_or_b32 v40, v117, 24, v40
v_cvt_pk_bf16_f32 v112, v82, v86
v_cvt_pk_bf16_f32 v113, v83, v87
v_cvt_pk_bf16_f32 v114, v84, v88
v_cvt_pk_bf16_f32 v115, v85, v89
v_cvt_pk_bf16_f32 v110, v90, v91
v_cvt_pk_bf16_f32 v111, v92, v93
v_lshlrev_b32 v116, 4, v0
v_lshlrev_b32 v117, 3, v0
ds_write_b128 v116, v[112:115] offset:30048
ds_write_b64 v117, v[110:111] offset:20048
v_mov_b32 v118, v66
v_mov_b32 v119, v67
v_mov_b32 v120, v68
v_mov_b32 v121, v69
v_mov_b32 v122, v70
v_mov_b32 v123, v71
v_mov_b32 v124, v72
v_mov_b32 v125, v73
s_cmp_ge_u32 s3, 4
s_cbranch_scc1 L_skip_e1_18
s_lshl_b32 s101, s36, 16
v_subrev_f32 v66, s101, v127
s_and_b32 s101, s36, s91
v_subrev_f32 v67, s101, v127
v_cvt_pk_bf16_f32 v116, v66, v67
v_lshlrev_b32 v66, 16, v116
v_and_b32 v67, s91, v116
v_mul_f32 v66, v66, v66
v_mul_f32 v67, v67, v67
v_cvt_pk_bf16_f32 v116, v66, v67
v_lshlrev_b32 v66, 16, v116
v_and_b32 v67, s91, v116
v_mul_f32 v66, 0xc1200000, v66
v_mul_f32 v67, 0xc1200000, v67
v_cvt_pk_bf16_f32 v116, v66, v67
v_lshlrev_b32 v66, 16, v116
v_and_b32 v67, s91, v116
v_mul_f32 v66, 0x3fb8aa3b, v66
v_mul_f32 v67, 0x3fb8aa3b, v67
v_exp_f32 v66, v66
v_exp_f32 v67, v67
s_nop 0
v_cvt_pk_bf16_f32 v116, v66, v67
v_lshlrev_b32 v66, 16, v116
v_and_b32 v67, s91, v116
s_lshl_b32 s101, s37, 16
v_subrev_f32 v68, s101, v127
s_and_b32 s101, s37, s91
v_subrev_f32 v69, s101, v127
v_cvt_pk_bf16_f32 v116, v68, v69
v_lshlrev_b32 v68, 16, v116
v_and_b32 v69, s91, v116
v_mul_f32 v68, v68, v68
v_mul_f32 v69, v69, v69
v_cvt_pk_bf16_f32 v116, v68, v69
v_lshlrev_b32 v68, 16, v116
v_and_b32 v69, s91, v116
v_mul_f32 v68, 0xc1200000, v68
v_mul_f32 v69, 0xc1200000, v69
v_cvt_pk_bf16_f32 v116, v68, v69
v_lshlrev_b32 v68, 16, v116
v_and_b32 v69, s91, v116
v_mul_f32 v68, 0x3fb8aa3b, v68
v_mul_f32 v69, 0x3fb8aa3b, v69
v_exp_f32 v68, v68
v_exp_f32 v69, v69
s_nop 0
v_cvt_pk_bf16_f32 v116, v68, v69
v_lshlrev_b32 v68, 16, v116
v_and_b32 v69, s91, v116
s_lshl_b32 s101, s38, 16
v_subrev_f32 v70, s101, v127
s_and_b32 s101, s38, s91
v_subrev_f32 v71, s101, v127
v_cvt_pk_bf16_f32 v116, v70, v71
v_lshlrev_b32 v70, 16, v116
v_and_b32 v71, s91, v116
v_mul_f32 v70, v70, v70
v_mul_f32 v71, v71, v71
v_cvt_pk_bf16_f32 v116, v70, v71
v_lshlrev_b32 v70, 16, v116
v_and_b32 v71, s91, v116
v_mul_f32 v70, 0xc1200000, v70
v_mul_f32 v71, 0xc1200000, v71
v_cvt_pk_bf16_f32 v116, v70, v71
v_lshlrev_b32 v70, 16, v116
v_and_b32 v71, s91, v116
v_mul_f32 v70, 0x3fb8aa3b, v70
v_mul_f32 v71, 0x3fb8aa3b, v71
v_exp_f32 v70, v70
v_exp_f32 v71, v71
s_nop 0
v_cvt_pk_bf16_f32 v116, v70, v71
v_lshlrev_b32 v70, 16, v116
v_and_b32 v71, s91, v116
s_lshl_b32 s101, s39, 16
v_subrev_f32 v72, s101, v127
s_and_b32 s101, s39, s91
v_subrev_f32 v73, s101, v127
v_cvt_pk_bf16_f32 v116, v72, v73
v_lshlrev_b32 v72, 16, v116
v_and_b32 v73, s91, v116
v_mul_f32 v72, v72, v72
v_mul_f32 v73, v73, v73
v_cvt_pk_bf16_f32 v116, v72, v73
v_lshlrev_b32 v72, 16, v116
v_and_b32 v73, s91, v116
v_mul_f32 v72, 0xc1200000, v72
v_mul_f32 v73, 0xc1200000, v73
v_cvt_pk_bf16_f32 v116, v72, v73
v_lshlrev_b32 v72, 16, v116
v_and_b32 v73, s91, v116
v_mul_f32 v72, 0x3fb8aa3b, v72
v_mul_f32 v73, 0x3fb8aa3b, v73
v_exp_f32 v72, v72
v_exp_f32 v73, v73
s_nop 0
v_cvt_pk_bf16_f32 v116, v72, v73
v_lshlrev_b32 v72, 16, v116
v_and_b32 v73, s91, v116
s_lshl_b32 s101, s40, 16
v_mul_f32 v82, s101, v66
s_and_b32 s101, s40, s91
v_mul_f32 v83, s101, v66
s_lshl_b32 s101, s41, 16
v_mul_f32 v84, s101, v66
s_and_b32 s101, s41, s91
v_mul_f32 v85, s101, v66
s_lshl_b32 s101, s42, 16
v_mul_f32 v86, s101, v66
s_and_b32 s101, s42, s91
v_mul_f32 v87, s101, v66
s_lshl_b32 s101, s43, 16
v_mul_f32 v88, s101, v66
s_and_b32 s101, s43, s91
v_mul_f32 v89, s101, v66
s_lshl_b32 s101, s44, 16
v_mul_f32 v90, s101, v66
s_and_b32 s101, s44, s91
v_mul_f32 v91, s101, v66
s_lshl_b32 s101, s45, 16
v_mul_f32 v92, s101, v66
s_and_b32 s101, s45, s91
v_mul_f32 v93, s101, v66
s_lshl_b32 s101, s46, 16
v_fmac_f32 v82, s101, v67
s_and_b32 s101, s46, s91
v_fmac_f32 v83, s101, v67
s_lshl_b32 s101, s47, 16
v_fmac_f32 v84, s101, v67
s_and_b32 s101, s47, s91
v_fmac_f32 v85, s101, v67
s_lshl_b32 s101, s48, 16
v_fmac_f32 v86, s101, v67
s_and_b32 s101, s48, s91
v_fmac_f32 v87, s101, v67
s_lshl_b32 s101, s49, 16
v_fmac_f32 v88, s101, v67
s_and_b32 s101, s49, s91
v_fmac_f32 v89, s101, v67
s_lshl_b32 s101, s50, 16
v_fmac_f32 v90, s101, v67
s_and_b32 s101, s50, s91
v_fmac_f32 v91, s101, v67
s_lshl_b32 s101, s51, 16
v_fmac_f32 v92, s101, v67
s_and_b32 s101, s51, s91
v_fmac_f32 v93, s101, v67
s_lshl_b32 s101, s52, 16
v_fmac_f32 v82, s101, v68
s_and_b32 s101, s52, s91
v_fmac_f32 v83, s101, v68
s_lshl_b32 s101, s53, 16
v_fmac_f32 v84, s101, v68
s_and_b32 s101, s53, s91
v_fmac_f32 v85, s101, v68
s_lshl_b32 s101, s54, 16
v_fmac_f32 v86, s101, v68
s_and_b32 s101, s54, s91
v_fmac_f32 v87, s101, v68
s_lshl_b32 s101, s55, 16
v_fmac_f32 v88, s101, v68
s_and_b32 s101, s55, s91
v_fmac_f32 v89, s101, v68
s_lshl_b32 s101, s56, 16
v_fmac_f32 v90, s101, v68
s_and_b32 s101, s56, s91
v_fmac_f32 v91, s101, v68
s_lshl_b32 s101, s57, 16
v_fmac_f32 v92, s101, v68
s_and_b32 s101, s57, s91
v_fmac_f32 v93, s101, v68
s_lshl_b32 s101, s58, 16
v_fmac_f32 v82, s101, v69
s_and_b32 s101, s58, s91
v_fmac_f32 v83, s101, v69
s_lshl_b32 s101, s59, 16
v_fmac_f32 v84, s101, v69
s_and_b32 s101, s59, s91
v_fmac_f32 v85, s101, v69
s_lshl_b32 s101, s60, 16
v_fmac_f32 v86, s101, v69
s_and_b32 s101, s60, s91
v_fmac_f32 v87, s101, v69
s_lshl_b32 s101, s61, 16
v_fmac_f32 v88, s101, v69
s_and_b32 s101, s61, s91
v_fmac_f32 v89, s101, v69
s_lshl_b32 s101, s62, 16
v_fmac_f32 v90, s101, v69
s_and_b32 s101, s62, s91
v_fmac_f32 v91, s101, v69
s_lshl_b32 s101, s63, 16
v_fmac_f32 v92, s101, v69
s_and_b32 s101, s63, s91
v_fmac_f32 v93, s101, v69
s_lshl_b32 s101, s64, 16
v_fmac_f32 v82, s101, v70
s_and_b32 s101, s64, s91
v_fmac_f32 v83, s101, v70
s_lshl_b32 s101, s65, 16
v_fmac_f32 v84, s101, v70
s_and_b32 s101, s65, s91
v_fmac_f32 v85, s101, v70
s_lshl_b32 s101, s66, 16
v_fmac_f32 v86, s101, v70
s_and_b32 s101, s66, s91
v_fmac_f32 v87, s101, v70
s_lshl_b32 s101, s67, 16
v_fmac_f32 v88, s101, v70
s_and_b32 s101, s67, s91
v_fmac_f32 v89, s101, v70
s_lshl_b32 s101, s68, 16
v_fmac_f32 v90, s101, v70
s_and_b32 s101, s68, s91
v_fmac_f32 v91, s101, v70
s_lshl_b32 s101, s69, 16
v_fmac_f32 v92, s101, v70
s_and_b32 s101, s69, s91
v_fmac_f32 v93, s101, v70
s_lshl_b32 s101, s70, 16
v_fmac_f32 v82, s101, v71
s_and_b32 s101, s70, s91
v_fmac_f32 v83, s101, v71
s_lshl_b32 s101, s71, 16
v_fmac_f32 v84, s101, v71
s_and_b32 s101, s71, s91
v_fmac_f32 v85, s101, v71
s_lshl_b32 s101, s72, 16
v_fmac_f32 v86, s101, v71
s_and_b32 s101, s72, s91
v_fmac_f32 v87, s101, v71
s_lshl_b32 s101, s73, 16
v_fmac_f32 v88, s101, v71
s_and_b32 s101, s73, s91
v_fmac_f32 v89, s101, v71
s_lshl_b32 s101, s74, 16
v_fmac_f32 v90, s101, v71
s_and_b32 s101, s74, s91
v_fmac_f32 v91, s101, v71
s_lshl_b32 s101, s75, 16
v_fmac_f32 v92, s101, v71
s_and_b32 s101, s75, s91
v_fmac_f32 v93, s101, v71
s_lshl_b32 s101, s76, 16
v_fmac_f32 v82, s101, v72
s_and_b32 s101, s76, s91
v_fmac_f32 v83, s101, v72
s_lshl_b32 s101, s77, 16
v_fmac_f32 v84, s101, v72
s_and_b32 s101, s77, s91
v_fmac_f32 v85, s101, v72
s_lshl_b32 s101, s78, 16
v_fmac_f32 v86, s101, v72
s_and_b32 s101, s78, s91
v_fmac_f32 v87, s101, v72
s_lshl_b32 s101, s79, 16
v_fmac_f32 v88, s101, v72
s_and_b32 s101, s79, s91
v_fmac_f32 v89, s101, v72
s_lshl_b32 s101, s80, 16
v_fmac_f32 v90, s101, v72
s_and_b32 s101, s80, s91
v_fmac_f32 v91, s101, v72
s_lshl_b32 s101, s81, 16
v_fmac_f32 v92, s101, v72
s_and_b32 s101, s81, s91
v_fmac_f32 v93, s101, v72
s_lshl_b32 s101, s82, 16
v_fmac_f32 v82, s101, v73
s_and_b32 s101, s82, s91
v_fmac_f32 v83, s101, v73
s_lshl_b32 s101, s83, 16
v_fmac_f32 v84, s101, v73
s_and_b32 s101, s83, s91
v_fmac_f32 v85, s101, v73
s_lshl_b32 s101, s84, 16
v_fmac_f32 v86, s101, v73
s_and_b32 s101, s84, s91
v_fmac_f32 v87, s101, v73
s_lshl_b32 s101, s85, 16
v_fmac_f32 v88, s101, v73
s_and_b32 s101, s85, s91
v_fmac_f32 v89, s101, v73
s_lshl_b32 s101, s86, 16
v_fmac_f32 v90, s101, v73
s_and_b32 s101, s86, s91
v_fmac_f32 v91, s101, v73
s_lshl_b32 s101, s87, 16
v_fmac_f32 v92, s101, v73
s_and_b32 s101, s87, s91
v_fmac_f32 v93, s101, v73
v_cvt_pk_bf16_f32 v116, v82, v83
v_lshlrev_b32 v82, 16, v116
v_and_b32 v83, s91, v116
v_cvt_pk_bf16_f32 v116, v84, v85
v_lshlrev_b32 v84, 16, v116
v_and_b32 v85, s91, v116
v_cvt_pk_bf16_f32 v116, v86, v87
v_lshlrev_b32 v86, 16, v116
v_and_b32 v87, s91, v116
v_cvt_pk_bf16_f32 v116, v88, v89
v_lshlrev_b32 v88, 16, v116
v_and_b32 v89, s91, v116
v_cvt_pk_bf16_f32 v116, v90, v91
v_lshlrev_b32 v90, 16, v116
v_and_b32 v91, s91, v116
v_cvt_pk_bf16_f32 v116, v92, v93
v_lshlrev_b32 v92, 16, v116
v_and_b32 v93, s91, v116
v_mov_b32 v41, 0
v_add_f32_e64 v117, |v82|, |v86|
v_add_f32_e64 v117, v117, |v90|
v_mul_f32 v117, v117, v106
v_rcp_f32 v117, v117
s_nop 0
v_mul_f32 v117, 0x47048e80, v117
v_and_b32 v117, 0x7f800000, v117
v_min_f32 v117, 0x71800000, v117
v_max_f32 v117, 0x01000000, v117
v_mul_f32 v82, v117, v82
v_mul_f32 v86, v117, v86
v_mul_f32 v90, v117, v90
v_lshrrev_b32 v117, 23, v117
v_lshl_or_b32 v41, v117, 0, v41
v_add_f32_e64 v117, |v83|, |v87|
v_add_f32_e64 v117, v117, |v91|
v_mul_f32 v117, v117, v107
v_rcp_f32 v117, v117
s_nop 0
v_mul_f32 v117, 0x47048e80, v117
v_and_b32 v117, 0x7f800000, v117
v_min_f32 v117, 0x71800000, v117
v_max_f32 v117, 0x01000000, v117
v_mul_f32 v83, v117, v83
v_mul_f32 v87, v117, v87
v_mul_f32 v91, v117, v91
v_lshrrev_b32 v117, 23, v117
v_lshl_or_b32 v41, v117, 8, v41
v_add_f32_e64 v117, |v84|, |v88|
v_add_f32_e64 v117, v117, |v92|
v_mul_f32 v117, v117, v108
v_rcp_f32 v117, v117
s_nop 0
v_mul_f32 v117, 0x47048e80, v117
v_and_b32 v117, 0x7f800000, v117
v_min_f32 v117, 0x71800000, v117
v_max_f32 v117, 0x01000000, v117
v_mul_f32 v84, v117, v84
v_mul_f32 v88, v117, v88
v_mul_f32 v92, v117, v92
v_lshrrev_b32 v117, 23, v117
v_lshl_or_b32 v41, v117, 16, v41
v_add_f32_e64 v117, |v85|, |v89|
v_add_f32_e64 v117, v117, |v93|
v_mul_f32 v117, v117, v109
v_rcp_f32 v117, v117
s_nop 0
v_mul_f32 v117, 0x47048e80, v117
v_and_b32 v117, 0x7f800000, v117
v_min_f32 v117, 0x71800000, v117
v_max_f32 v117, 0x01000000, v117
v_mul_f32 v85, v117, v85
v_mul_f32 v89, v117, v89
v_mul_f32 v93, v117, v93
v_lshrrev_b32 v117, 23, v117
v_lshl_or_b32 v41, v117, 24, v41
v_cvt_pk_bf16_f32 v112, v82, v86
v_cvt_pk_bf16_f32 v113, v83, v87
v_cvt_pk_bf16_f32 v114, v84, v88
v_cvt_pk_bf16_f32 v115, v85, v89
v_cvt_pk_bf16_f32 v110, v90, v91
v_cvt_pk_bf16_f32 v111, v92, v93
v_lshlrev_b32 v116, 4, v0
v_lshlrev_b32 v117, 3, v0
v_cmp_gt_u32 vcc, 226, v0
s_and_saveexec_b64 s[96:97], vcc
ds_write_b128 v116, v[112:115] offset:46432
ds_write_b64 v117, v[110:111] offset:28240
s_mov_b64 exec, s[96:97]
L_skip_e1_18:
s_load_dwordx16 s[36:51], s[94:95], 0
s_waitcnt lgkmcnt(0)
s_cmp_ge_u32 s3, 4
s_cbranch_scc1 L_skip_h1_19
s_lshl_b32 s101, s36, 16
v_mul_f32 v82, s101, v66
s_and_b32 s101, s36, s91
v_mul_f32 v83, s101, v66
s_lshl_b32 s101, s37, 16
v_mul_f32 v84, s101, v66
s_and_b32 s101, s37, s91
v_mul_f32 v85, s101, v66
s_lshl_b32 s101, s38, 16
v_fmac_f32 v82, s101, v67
s_and_b32 s101, s38, s91
v_fmac_f32 v83, s101, v67
s_lshl_b32 s101, s39, 16
v_fmac_f32 v84, s101, v67
s_and_b32 s101, s39, s91
v_fmac_f32 v85, s101, v67
s_lshl_b32 s101, s40, 16
v_fmac_f32 v82, s101, v68
s_and_b32 s101, s40, s91
v_fmac_f32 v83, s101, v68
s_lshl_b32 s101, s41, 16
v_fmac_f32 v84, s101, v68
s_and_b32 s101, s41, s91
v_fmac_f32 v85, s101, v68
s_lshl_b32 s101, s42, 16
v_fmac_f32 v82, s101, v69
s_and_b32 s101, s42, s91
v_fmac_f32 v83, s101, v69
s_lshl_b32 s101, s43, 16
v_fmac_f32 v84, s101, v69
s_and_b32 s101, s43, s91
v_fmac_f32 v85, s101, v69
s_lshl_b32 s101, s44, 16
v_fmac_f32 v82, s101, v70
s_and_b32 s101, s44, s91
v_fmac_f32 v83, s101, v70
s_lshl_b32 s101, s45, 16
v_fmac_f32 v84, s101, v70
s_and_b32 s101, s45, s91
v_fmac_f32 v85, s101, v70
s_lshl_b32 s101, s46, 16
v_fmac_f32 v82, s101, v71
s_and_b32 s101, s46, s91
v_fmac_f32 v83, s101, v71
s_lshl_b32 s101, s47, 16
v_fmac_f32 v84, s101, v71
s_and_b32 s101, s47, s91
v_fmac_f32 v85, s101, v71
s_lshl_b32 s101, s48, 16
v_fmac_f32 v82, s101, v72
s_and_b32 s101, s48, s91
v_fmac_f32 v83, s101, v72
s_lshl_b32 s101, s49, 16
v_fmac_f32 v84, s101, v72
s_and_b32 s101, s49, s91
v_fmac_f32 v85, s101, v72
s_lshl_b32 s101, s50, 16
v_fmac_f32 v82, s101, v73
s_and_b32 s101, s50, s91
v_fmac_f32 v83, s101, v73
s_lshl_b32 s101, s51, 16
v_fmac_f32 v84, s101, v73
s_and_b32 s101, s51, s91
v_fmac_f32 v85, s101, v73
v_cvt_pk_bf16_f32 v38, v82, v83
v_cvt_pk_bf16_f32 v39, v84, v85
L_skip_h1_19:
v_mov_b32 v66, v118
v_mov_b32 v67, v119
v_mov_b32 v68, v120
v_mov_b32 v69, v121
v_mov_b32 v70, v122
v_mov_b32 v71, v123
v_mov_b32 v72, v124
v_mov_b32 v73, v125
s_lshl_b32 s101, s36, 16
v_mul_f32 v82, s101, v66
s_and_b32 s101, s36, s91
v_mul_f32 v83, s101, v66
s_lshl_b32 s101, s37, 16
v_mul_f32 v84, s101, v66
s_and_b32 s101, s37, s91
v_mul_f32 v85, s101, v66
s_lshl_b32 s101, s38, 16
v_fmac_f32 v82, s101, v67
s_and_b32 s101, s38, s91
v_fmac_f32 v83, s101, v67
s_lshl_b32 s101, s39, 16
v_fmac_f32 v84, s101, v67
s_and_b32 s101, s39, s91
v_fmac_f32 v85, s101, v67
s_lshl_b32 s101, s40, 16
v_fmac_f32 v82, s101, v68
s_and_b32 s101, s40, s91
v_fmac_f32 v83, s101, v68
s_lshl_b32 s101, s41, 16
v_fmac_f32 v84, s101, v68
s_and_b32 s101, s41, s91
v_fmac_f32 v85, s101, v68
s_lshl_b32 s101, s42, 16
v_fmac_f32 v82, s101, v69
s_and_b32 s101, s42, s91
v_fmac_f32 v83, s101, v69
s_lshl_b32 s101, s43, 16
v_fmac_f32 v84, s101, v69
s_and_b32 s101, s43, s91
v_fmac_f32 v85, s101, v69
s_lshl_b32 s101, s44, 16
v_fmac_f32 v82, s101, v70
s_and_b32 s101, s44, s91
v_fmac_f32 v83, s101, v70
s_lshl_b32 s101, s45, 16
v_fmac_f32 v84, s101, v70
s_and_b32 s101, s45, s91
v_fmac_f32 v85, s101, v70
s_lshl_b32 s101, s46, 16
v_fmac_f32 v82, s101, v71
s_and_b32 s101, s46, s91
v_fmac_f32 v83, s101, v71
s_lshl_b32 s101, s47, 16
v_fmac_f32 v84, s101, v71
s_and_b32 s101, s47, s91
v_fmac_f32 v85, s101, v71
s_lshl_b32 s101, s48, 16
v_fmac_f32 v82, s101, v72
s_and_b32 s101, s48, s91
v_fmac_f32 v83, s101, v72
s_lshl_b32 s101, s49, 16
v_fmac_f32 v84, s101, v72
s_and_b32 s101, s49, s91
v_fmac_f32 v85, s101, v72
s_lshl_b32 s101, s50, 16
v_fmac_f32 v82, s101, v73
s_and_b32 s101, s50, s91
v_fmac_f32 v83, s101, v73
s_lshl_b32 s101, s51, 16
v_fmac_f32 v84, s101, v73
s_and_b32 s101, s51, s91
v_fmac_f32 v85, s101, v73
v_cvt_pk_bf16_f32 v36, v82, v83
v_cvt_pk_bf16_f32 v37, v84, v85
v_mov_b32 v28, 0
v_mov_b32 v29, 0
v_mov_b32 v30, 0
v_mov_b32 v31, 0
v_mov_b32 v32, 0
v_mov_b32 v33, 0
v_mov_b32 v34, 0
v_mov_b32 v35, 0
v_mov_b32 v80, 0x3f800400
s_mov_b32 s29, 0x04020100
s_mov_b32 s31, 0x05020100
s_mov_b32 s15, 0x06020100
s_mov_b32 s94, 0x07020100
s_waitcnt vmcnt(0)
v_and_b32 v120, 1, v60
v_lshrrev_b32 v81, 24, v42
v_cmp_ne_u32 s[36:37], 0, v120
v_lshl_add_u32 v120, v81, 2, s100
s_mov_b64 exec, s[36:37]
ds_add_rtn_u32 v66, v120, v1
s_mov_b64 exec, -1
v_and_b32 v120, 2, v60
v_lshrrev_b32 v82, 24, v43
v_cmp_ne_u32 s[38:39], 0, v120
v_lshl_add_u32 v120, v82, 2, s100
s_mov_b64 exec, s[38:39]
ds_add_rtn_u32 v67, v120, v1
s_mov_b64 exec, -1
v_and_b32 v120, 4, v60
v_lshrrev_b32 v83, 24, v44
v_cmp_ne_u32 s[40:41], 0, v120
v_lshl_add_u32 v120, v83, 2, s100
s_mov_b64 exec, s[40:41]
ds_add_rtn_u32 v68, v120, v1
s_mov_b64 exec, -1
v_and_b32 v120, 8, v60
v_lshrrev_b32 v84, 24, v45
v_cmp_ne_u32 s[42:43], 0, v120
v_lshl_add_u32 v120, v84, 2, s100
s_mov_b64 exec, s[42:43]
ds_add_rtn_u32 v69, v120, v1
s_mov_b64 exec, -1
v_and_b32 v120, 1, v61
v_lshrrev_b32 v85, 24, v46
v_cmp_ne_u32 s[44:45], 0, v120
v_lshl_add_u32 v120, v85, 2, s100
s_mov_b64 exec, s[44:45]
ds_add_rtn_u32 v70, v120, v1
s_mov_b64 exec, -1
v_and_b32 v120, 2, v61
v_lshrrev_b32 v86, 24, v47
v_cmp_ne_u32 s[46:47], 0, v120
v_lshl_add_u32 v120, v86, 2, s100
s_mov_b64 exec, s[46:47]
ds_add_rtn_u32 v71, v120, v1
s_mov_b64 exec, -1
v_and_b32 v120, 4, v61
v_lshrrev_b32 v87, 24, v48
v_cmp_ne_u32 s[48:49], 0, v120
v_lshl_add_u32 v120, v87, 2, s100
s_mov_b64 exec, s[48:49]
ds_add_rtn_u32 v72, v120, v1
s_mov_b64 exec, -1
s_waitcnt lgkmcnt(6)
v_cmp_gt_u32 vcc, 64, v66
v_lshl_add_u32 v120, v81, 6, v66
v_perm_b32 v64, v54, v42, s29
s_andn2_b64 s[66:67], s[36:37], vcc
s_and_b64 exec, s[36:37], vcc
v_lshl_add_u32 v120, v120, 2, s28
ds_write_b32 v120, v64
s_mov_b64 exec, -1
s_mov_b64 s[36:37], s[66:67]
v_and_b32 v120, 8, v61
v_lshrrev_b32 v88, 24, v49
v_cmp_ne_u32 s[50:51], 0, v120
v_lshl_add_u32 v120, v88, 2, s100
s_mov_b64 exec, s[50:51]
ds_add_rtn_u32 v73, v120, v1
s_mov_b64 exec, -1
s_waitcnt lgkmcnt(7)
v_cmp_gt_u32 vcc, 64, v67
v_lshl_add_u32 v120, v82, 6, v67
v_perm_b32 v64, v54, v43, s31
s_andn2_b64 s[66:67], s[38:39], vcc
s_and_b64 exec, s[38:39], vcc
v_lshl_add_u32 v120, v120, 2, s28
ds_write_b32 v120, v64
s_mov_b64 exec, -1
s_mov_b64 s[38:39], s[66:67]
v_and_b32 v120, 1, v62
v_lshrrev_b32 v89, 24, v50
v_cmp_ne_u32 s[52:53], 0, v120
v_lshl_add_u32 v120, v89, 2, s100
s_mov_b64 exec, s[52:53]
ds_add_rtn_u32 v74, v120, v1
s_mov_b64 exec, -1
s_waitcnt lgkmcnt(8)
v_cmp_gt_u32 vcc, 64, v68
v_lshl_add_u32 v120, v83, 6, v68
v_perm_b32 v64, v54, v44, s15
s_andn2_b64 s[66:67], s[40:41], vcc
s_and_b64 exec, s[40:41], vcc
v_lshl_add_u32 v120, v120, 2, s28
ds_write_b32 v120, v64
s_mov_b64 exec, -1
s_mov_b64 s[40:41], s[66:67]
v_and_b32 v120, 2, v62
v_lshrrev_b32 v90, 24, v51
v_cmp_ne_u32 s[54:55], 0, v120
v_lshl_add_u32 v120, v90, 2, s100
s_mov_b64 exec, s[54:55]
ds_add_rtn_u32 v75, v120, v1
s_mov_b64 exec, -1
s_waitcnt lgkmcnt(9)
v_cmp_gt_u32 vcc, 64, v69
v_lshl_add_u32 v120, v84, 6, v69
v_perm_b32 v64, v54, v45, s94
s_andn2_b64 s[66:67], s[42:43], vcc
s_and_b64 exec, s[42:43], vcc
v_lshl_add_u32 v120, v120, 2, s28
ds_write_b32 v120, v64
s_mov_b64 exec, -1
s_mov_b64 s[42:43], s[66:67]
v_and_b32 v120, 4, v62
v_lshrrev_b32 v91, 24, v52
v_cmp_ne_u32 s[56:57], 0, v120
v_lshl_add_u32 v120, v91, 2, s100
s_mov_b64 exec, s[56:57]
ds_add_rtn_u32 v76, v120, v1
s_mov_b64 exec, -1
s_waitcnt lgkmcnt(10)
v_cmp_gt_u32 vcc, 64, v70
v_lshl_add_u32 v120, v85, 6, v70
v_perm_b32 v64, v55, v46, s29
s_andn2_b64 s[66:67], s[44:45], vcc
s_and_b64 exec, s[44:45], vcc
v_lshl_add_u32 v120, v120, 2, s28
ds_write_b32 v120, v64
s_mov_b64 exec, -1
s_mov_b64 s[44:45], s[66:67]
v_and_b32 v120, 8, v62
v_lshrrev_b32 v92, 24, v53
v_cmp_ne_u32 s[58:59], 0, v120
v_lshl_add_u32 v120, v92, 2, s100
s_mov_b64 exec, s[58:59]
ds_add_rtn_u32 v77, v120, v1
s_mov_b64 exec, -1
s_waitcnt lgkmcnt(11)
v_cmp_gt_u32 vcc, 64, v71
v_lshl_add_u32 v120, v86, 6, v71
v_perm_b32 v64, v55, v47, s31
s_andn2_b64 s[66:67], s[46:47], vcc
s_and_b64 exec, s[46:47], vcc
v_lshl_add_u32 v120, v120, 2, s28
ds_write_b32 v120, v64
s_mov_b64 exec, -1
s_mov_b64 s[46:47], s[66:67]
s_waitcnt lgkmcnt(11)
v_cmp_gt_u32 vcc, 64, v72
v_lshl_add_u32 v120, v87, 6, v72
v_perm_b32 v64, v55, v48, s15
s_andn2_b64 s[66:67], s[48:49], vcc
s_and_b64 exec, s[48:49], vcc
v_lshl_add_u32 v120, v120, 2, s28
ds_write_b32 v120, v64
s_mov_b64 exec, -1
s_mov_b64 s[48:49], s[66:67]
s_waitcnt lgkmcnt(10)
v_cmp_gt_u32 vcc, 64, v73
v_lshl_add_u32 v120, v88, 6, v73
v_perm_b32 v64, v55, v49, s94
s_andn2_b64 s[66:67], s[50:51], vcc
s_and_b64 exec, s[50:51], vcc
v_lshl_add_u32 v120, v120, 2, s28
ds_write_b32 v120, v64
s_mov_b64 exec, -1
s_mov_b64 s[50:51], s[66:67]
s_waitcnt lgkmcnt(9)
v_cmp_gt_u32 vcc, 64, v74
v_lshl_add_u32 v120, v89, 6, v74
v_perm_b32 v64, v56, v50, s29
s_andn2_b64 s[66:67], s[52:53], vcc
s_and_b64 exec, s[52:53], vcc
v_lshl_add_u32 v120, v120, 2, s28
ds_write_b32 v120, v64
s_mov_b64 exec, -1
s_mov_b64 s[52:53], s[66:67]
s_waitcnt lgkmcnt(8)
v_cmp_gt_u32 vcc, 64, v75
v_lshl_add_u32 v120, v90, 6, v75
v_perm_b32 v64, v56, v51, s31
s_andn2_b64 s[66:67], s[54:55], vcc
s_and_b64 exec, s[54:55], vcc
v_lshl_add_u32 v120, v120, 2, s28
ds_write_b32 v120, v64
s_mov_b64 exec, -1
s_mov_b64 s[54:55], s[66:67]
s_waitcnt lgkmcnt(7)
v_cmp_gt_u32 vcc, 64, v76
v_lshl_add_u32 v120, v91, 6, v76
v_perm_b32 v64, v56, v52, s15
s_andn2_b64 s[66:67], s[56:57], vcc
s_and_b64 exec, s[56:57], vcc
v_lshl_add_u32 v120, v120, 2, s28
ds_write_b32 v120, v64
s_mov_b64 exec, -1
s_mov_b64 s[56:57], s[66:67]
s_waitcnt lgkmcnt(6)
v_cmp_gt_u32 vcc, 64, v77
v_lshl_add_u32 v120, v92, 6, v77
v_perm_b32 v64, v56, v53, s94
s_andn2_b64 s[66:67], s[58:59], vcc
s_and_b64 exec, s[58:59], vcc
v_lshl_add_u32 v120, v120, 2, s28
ds_write_b32 v120, v64
s_mov_b64 exec, -1
s_mov_b64 s[58:59], s[66:67]
s_mov_b32 s65, 0
s_mov_b32 s14, 0
s_waitcnt lgkmcnt(0)
s_barrier
s_cmp_eq_u64 s[36:37], 0
s_cbranch_scc1 L_defslow_32
s_mov_b64 s[66:67], s[36:37]
v_perm_b32 v64, v54, v42, s29
v_mov_b32 v63, v42
s_call_b64 s[98:99], L_k2_slow
L_defslow_32:
s_cmp_eq_u64 s[38:39], 0
s_cbranch_scc1 L_defslow_33
s_mov_b64 s[66:67], s[38:39]
v_perm_b32 v64, v54, v43, s31
v_mov_b32 v63, v43
s_call_b64 s[98:99], L_k2_slow
L_defslow_33:
s_cmp_eq_u64 s[40:41], 0
s_cbranch_scc1 L_defslow_34
s_mov_b64 s[66:67], s[40:41]
v_perm_b32 v64, v54, v44, s15
v_mov_b32 v63, v44
s_call_b64 s[98:99], L_k2_slow
L_defslow_34:
s_cmp_eq_u64 s[42:43], 0
s_cbranch_scc1 L_defslow_35
s_mov_b64 s[66:67], s[42:43]
v_perm_b32 v64, v54, v45, s94
v_mov_b32 v63, v45
s_call_b64 s[98:99], L_k2_slow
L_defslow_35:
s_cmp_eq_u64 s[44:45], 0
s_cbranch_scc1 L_defslow_36
s_mov_b64 s[66:67], s[44:45]
v_perm_b32 v64, v55, v46, s29
v_mov_b32 v63, v46
s_call_b64 s[98:99], L_k2_slow
L_defslow_36:
s_cmp_eq_u64 s[46:47], 0
s_cbranch_scc1 L_defslow_37
s_mov_b64 s[66:67], s[46:47]
v_perm_b32 v64, v55, v47, s31
v_mov_b32 v63, v47
s_call_b64 s[98:99], L_k2_slow
L_defslow_37:
s_cmp_eq_u64 s[48:49], 0
s_cbranch_scc1 L_defslow_38
s_mov_b64 s[66:67], s[48:49]
v_perm_b32 v64, v55, v48, s15
v_mov_b32 v63, v48
s_call_b64 s[98:99], L_k2_slow
L_defslow_38:
s_cmp_eq_u64 s[50:51], 0
s_cbranch_scc1 L_defslow_39
s_mov_b64 s[66:67], s[50:51]
v_perm_b32 v64, v55, v49, s94
v_mov_b32 v63, v49
s_call_b64 s[98:99], L_k2_slow
L_defslow_39:
s_cmp_eq_u64 s[52:53], 0
s_cbranch_scc1 L_defslow_40
s_mov_b64 s[66:67], s[52:53]
v_perm_b32 v64, v56, v50, s29
v_mov_b32 v63, v50
s_call_b64 s[98:99], L_k2_slow
L_defslow_40:
s_cmp_eq_u64 s[54:55], 0
s_cbranch_scc1 L_defslow_41
s_mov_b64 s[66:67], s[54:55]
v_perm_b32 v64, v56, v51, s31
v_mov_b32 v63, v51
s_call_b64 s[98:99], L_k2_slow
L_defslow_41:
s_cmp_eq_u64 s[56:57], 0
s_cbranch_scc1 L_defslow_42
s_mov_b64 s[66:67], s[56:57]
v_perm_b32 v64, v56, v52, s15
v_mov_b32 v63, v52
s_call_b64 s[98:99], L_k2_slow
L_defslow_42:
s_cmp_eq_u64 s[58:59], 0
s_cbranch_scc1 L_defslow_43
s_mov_b64 s[66:67], s[58:59]
v_perm_b32 v64, v56, v53, s94
v_mov_b32 v63, v53
s_call_b64 s[98:99], L_k2_slow
L_defslow_43:
L_k2_batch:
s_mov_b32 s64, s100
s_xor_b32 s100, s100, 1152
s_mov_b32 s89, s93
s_mov_b32 s92, s8
s_mov_b32 s93, s9
s_mov_b32 s13, s12
L_guard_44:
ds_read_b32 v2, v25 offset:20036
s_waitcnt lgkmcnt(0)
v_readfirstlane_b32 s101, v2
s_nop 0
s_cmp_ge_u32 s101, s14
s_cbranch_scc1 L_guard_ok_45
s_sleep 1
s_branch L_guard_44
L_guard_ok_45:
v_add_u32 v27, s13, v23
ds_read_b32 v60, v27 offset:0
ds_read_b32 v61, v27 offset:4096
ds_read_b32 v62, v27 offset:8192
v_add_u32 v2, s64, v19
s_waitcnt lgkmcnt(0)
ds_read_b32 v102, v2 offset:0
ds_read_b32 v103, v2 offset:64
ds_read_b32 v104, v2 offset:128
ds_read_b32 v105, v2 offset:192
ds_read_b32 v106, v2 offset:256
ds_read_b32 v107, v2 offset:320
ds_read_b32 v108, v2 offset:384
ds_read_b32 v109, v2 offset:448
ds_read_b32 v110, v2 offset:512
ds_read_b32 v111, v2 offset:576
ds_read_b32 v112, v2 offset:640
ds_read_b32 v113, v2 offset:704
ds_read_b32 v114, v2 offset:768
ds_read_b32 v115, v2 offset:832
s_waitcnt lgkmcnt(0)
v_add_u32 v2, s64, v26
s_mov_b64 exec, 16383
ds_write_b32 v2, v25
s_mov_b64 exec, -1
ds_read2st64_b32 v[66:67], v20 offset0:0 offset1:16
ds_read2st64_b32 v[68:69], v20 offset0:32 offset1:48
ds_read2st64_b32 v[70:71], v20 offset0:64 offset1:80
ds_read2st64_b32 v[72:73], v20 offset0:96 offset1:112
ds_read2st64_b32 v[74:75], v20 offset0:128 offset1:144
ds_read2st64_b32 v[76:77], v20 offset0:160 offset1:176
ds_read2st64_b32 v[78:79], v20 offset0:192 offset1:208
v_cmp_gt_u32 s[36:37], v102, v18
v_cmp_gt_u32 s[38:39], v103, v18
v_cmp_gt_u32 s[40:41], v104, v18
v_cmp_gt_u32 s[42:43], v105, v18
v_cmp_gt_u32 s[44:45], v106, v18
v_cmp_gt_u32 s[46:47], v107, v18
v_cmp_gt_u32 s[48:49], v108, v18
v_cmp_gt_u32 s[50:51], v109, v18
v_cmp_gt_u32 s[52:53], v110, v18
v_cmp_gt_u32 s[54:55], v111, v18
v_cmp_gt_u32 s[56:57], v112, v18
v_cmp_gt_u32 s[58:59], v113, v18
v_cmp_gt_u32 s[60:61], v114, v18
v_cmp_gt_u32 s[62:63], v115, v18
s_add_u32 s90, s89, s3
s_mul_i32 s90, s90, 3072
s_mov_b64 exec, 1
ds_add_u32 v25, v1 offset:20032
s_mov_b64 exec, -1
s_add_u32 s14, s14, 16
s_setprio 3
s_waitcnt lgkmcnt(1)
v_and_b32 v2, 0x1ff, v66
s_add_u32 s101, s90, 0
s_mov_b64 exec, s[36:37]
buffer_load_dwordx2 v[94:95], v2, s[24:27], s101 idxen
s_mov_b64 exec, -1
v_and_b32 v2, 0x1ff, v67
s_add_u32 s101, s90, 49152
s_mov_b64 exec, s[38:39]
buffer_load_dwordx2 v[96:97], v2, s[24:27], s101 idxen
s_mov_b64 exec, -1
v_and_b32 v2, 0x1ff, v68
s_add_u32 s101, s90, 98304
s_mov_b64 exec, s[40:41]
buffer_load_dwordx2 v[98:99], v2, s[24:27], s101 idxen
s_mov_b64 exec, -1
s_waitcnt lgkmcnt(0)
s_add_u32 s7, s7, 3072
L_nb_loop_46:
s_cmp_ge_u32 s6, 4
s_cbranch_scc1 L_nb_end_48
s_mov_b32 s8, s32
s_mov_b32 s9, 0
s_cmp_eq_u32 s6, 1
s_cselect_b32 s8, s33, s8
s_cselect_b32 s9, 210, s9
s_cmp_eq_u32 s6, 2
s_cselect_b32 s8, s34, s8
s_cselect_b32 s9, 420, s9
s_cmp_eq_u32 s6, 3
s_cselect_b32 s8, s35, s8
s_cselect_b32 s9, 630, s9
s_cmp_lt_u32 s7, s8
s_cbranch_scc1 L_nb_done_47
s_add_u32 s6, s6, 1
s_mov_b32 s7, 0
s_branch L_nb_loop_46
L_nb_end_48:
s_mov_b32 s8, 0
s_mov_b32 s7, 0
L_nb_done_47:
s_sub_u32 s8, s8, s7
s_min_u32 s8, s8, 3072
s_xor_b32 s12, s12, 69632
s_cmp_eq_u32 s8, 0
s_cbranch_scc1 L_build_done_50
v_mov_b32 v2, v10
v_mov_b32 v3, v14
s_cmp_lg_u32 s6, 1
s_cbranch_scc1 L_bq_51
v_mov_b32 v2, v11
v_mov_b32 v3, v15
L_bq_51:
s_cmp_lg_u32 s6, 2
s_cbranch_scc1 L_bq_52
v_mov_b32 v2, v12
v_mov_b32 v3, v16
L_bq_52:
s_cmp_lg_u32 s6, 3
s_cbranch_scc1 L_bq_53
v_mov_b32 v2, v13
v_mov_b32 v3, v17
L_bq_53:
v_lshrrev_b32 v5, 1, v0
v_mul_u32_u24 v5, 20000, v5
v_and_b32 v4, 0xffff, v2
v_add_u32 v4, v4, v5
v_lshrrev_b32 v2, 16, v2
v_add_u32 v5, v4, v2
v_add_u32 v6, 3, v5
v_cmp_eq_u32 vcc, 0, v2
v_lshrrev_b32 v6, 2, v6
v_lshrrev_b32 v7, 2, v4
v_sub_u32 v6, v6, v7
v_sub_u32 v8, s7, v3
v_cndmask_b32_e64 v6, v6, 0, vcc
v_max_i32 v8, 0, v8
v_xor_b32 v2, v8, v22
v_and_b32 v2, 1, v2
v_add_u32 v8, v8, v2
v_subrev_u32 v3, s7, v3
s_mov_b64 s[96:97], exec
L_build_49:
v_add_u32 v2, v3, v8
v_cmp_lt_u32 vcc, v8, v6
v_cmp_gt_u32 s[98:99], s30, v2
s_and_b64 vcc, vcc, s[98:99]
s_and_b64 exec, exec, vcc
s_cbranch_execz L_build_restore_54
v_add_u32 v9, v7, v8
v_lshlrev_b32 v120, 2, v9
v_max_u32 v121, v120, v4
v_sub_u32 v121, v121, v120
v_sub_u32 v120, v5, v120
v_min_u32 v120, 4, v120
v_sub_u32 v120, v120, v121
v_bfm_b32 v120, v120, v121
v_lshl_or_b32 v9, v9, 4, v120
v_lshl_add_u32 v2, v2, 2, s12
ds_write_b32 v2, v9
v_add_u32 v8, 2, v8
s_branch L_build_49
L_build_restore_54:
s_mov_b64 exec, s[96:97]
L_build_done_50:
s_waitcnt lgkmcnt(0)
s_sub_i32 s101, s92, 0
s_max_i32 s101, s101, 0
v_cmp_gt_u32 vcc, s101, v0
v_lshrrev_b32 v120, 4, v60
v_and_b32 v60, 15, v60
v_mul_u32_u24 v120, 20, v120
v_cndmask_b32_e64 v60, 0, v60, vcc
s_mov_b64 exec, vcc
buffer_load_dwordx4 v[42:45], v120, s[20:23], 0 offen
buffer_load_dword v54, v120, s[20:23], 0 offen offset:16
s_mov_b64 exec, -1
s_sub_i32 s101, s92, 1024
s_max_i32 s101, s101, 0
v_cmp_gt_u32 vcc, s101, v0
v_lshrrev_b32 v120, 4, v61
v_and_b32 v61, 15, v61
v_mul_u32_u24 v120, 20, v120
v_cndmask_b32_e64 v61, 0, v61, vcc
s_mov_b64 exec, vcc
buffer_load_dwordx4 v[46:49], v120, s[20:23], 0 offen
buffer_load_dword v55, v120, s[20:23], 0 offen offset:16
s_mov_b64 exec, -1
s_waitcnt vmcnt(2)
v_and_b32 v120, 1, v60
v_lshrrev_b32 v126, 24, v42
v_cmp_ne_u32 s[68:69], 0, v120
v_lshl_add_u32 v120, v126, 2, s100
s_mov_b64 exec, s[68:69]
ds_add_rtn_u32 v124, v120, v1
s_mov_b64 exec, -1
v_and_b32 v120, 2, v60
v_lshrrev_b32 v127, 24, v43
v_cmp_ne_u32 s[70:71], 0, v120
v_lshl_add_u32 v120, v127, 2, s100
s_mov_b64 exec, s[70:71]
ds_add_rtn_u32 v125, v120, v1
s_mov_b64 exec, -1
s_setprio 2
L_guard_55:
ds_read_b32 v2, v25 offset:20032
s_waitcnt lgkmcnt(0)
v_readfirstlane_b32 s101, v2
s_nop 0
s_cmp_ge_u32 s101, s14
s_cbranch_scc1 L_guard_ok_56
s_sleep 1
s_branch L_guard_55
L_guard_ok_56:
v_cmp_gt_u32 vcc, 64, v124
v_lshl_add_u32 v120, v126, 6, v124
v_perm_b32 v64, v54, v42, s29
s_andn2_b64 s[66:67], s[68:69], vcc
s_and_b64 exec, s[68:69], vcc
v_lshl_add_u32 v120, v120, 2, s28
ds_write_b32 v120, v64
s_mov_b64 exec, -1
s_cmp_eq_u64 s[66:67], 0
s_cbranch_scc1 L_noovf_57
v_mov_b32 v63, v42
s_call_b64 s[98:99], L_k2_slow
L_noovf_57:
v_cmp_gt_u32 vcc, 64, v125
v_lshl_add_u32 v120, v127, 6, v125
v_perm_b32 v64, v54, v43, s31
s_andn2_b64 s[66:67], s[70:71], vcc
s_and_b64 exec, s[70:71], vcc
v_lshl_add_u32 v120, v120, 2, s28
ds_write_b32 v120, v64
s_mov_b64 exec, -1
s_cmp_eq_u64 s[66:67], 0
s_cbranch_scc1 L_noovf_58
v_mov_b32 v63, v43
s_call_b64 s[98:99], L_k2_slow
L_noovf_58:
s_sub_i32 s101, s92, 2048
s_max_i32 s101, s101, 0
v_cmp_gt_u32 vcc, s101, v0
v_lshrrev_b32 v120, 4, v62
v_and_b32 v62, 15, v62
v_mul_u32_u24 v120, 20, v120
v_cndmask_b32_e64 v62, 0, v62, vcc
s_mov_b64 exec, vcc
buffer_load_dwordx4 v[50:53], v120, s[20:23], 0 offen
buffer_load_dword v56, v120, s[20:23], 0 offen offset:16
s_mov_b64 exec, -1
s_waitcnt vmcnt(4)
v_and_b32 v120, 4, v60
v_lshrrev_b32 v126, 24, v44
v_cmp_ne_u32 s[68:69], 0, v120
v_lshl_add_u32 v120, v126, 2, s100
s_mov_b64 exec, s[68:69]
ds_add_rtn_u32 v124, v120, v1
s_mov_b64 exec, -1
v_and_b32 v120, 8, v60
v_lshrrev_b32 v127, 24, v45
v_cmp_ne_u32 s[70:71], 0, v120
v_lshl_add_u32 v120, v127, 2, s100
s_mov_b64 exec, s[70:71]
ds_add_rtn_u32 v125, v120, v1
s_mov_b64 exec, -1
s_waitcnt lgkmcnt(0)
v_cmp_gt_u32 vcc, 64, v124
v_lshl_add_u32 v120, v126, 6, v124
v_perm_b32 v64, v54, v44, s15
s_andn2_b64 s[66:67], s[68:69], vcc
s_and_b64 exec, s[68:69], vcc
v_lshl_add_u32 v120, v120, 2, s28
ds_write_b32 v120, v64
s_mov_b64 exec, -1
s_cmp_eq_u64 s[66:67], 0
s_cbranch_scc1 L_noovf_59
v_mov_b32 v63, v44
s_call_b64 s[98:99], L_k2_slow
L_noovf_59:
v_cmp_gt_u32 vcc, 64, v125
v_lshl_add_u32 v120, v127, 6, v125
v_perm_b32 v64, v54, v45, s94
s_andn2_b64 s[66:67], s[70:71], vcc
s_and_b64 exec, s[70:71], vcc
v_lshl_add_u32 v120, v120, 2, s28
ds_write_b32 v120, v64
s_mov_b64 exec, -1
s_cmp_eq_u64 s[66:67], 0
s_cbranch_scc1 L_noovf_60
v_mov_b32 v63, v45
s_call_b64 s[98:99], L_k2_slow
L_noovf_60:
s_mov_b64 exec, s[36:37]
v_lshrrev_b32 v111, 6, v66
v_and_b32 v111, 0x3ff8, v111
v_add_u32 v112, v111, v111
ds_read_b128 v[102:105], v112 offset:30048
ds_read_b64 v[106:107], v111 offset:20048
s_mov_b64 exec, -1
v_and_b32 v2, 0x1ff, v69
s_add_u32 s101, s90, 147456
s_mov_b64 exec, s[42:43]
buffer_load_dwordx2 v[100:101], v2, s[24:27], s101 idxen
s_mov_b64 exec, -1
s_waitcnt vmcnt(3)
v_and_b32 v120, 1, v61
v_lshrrev_b32 v126, 24, v46
v_cmp_ne_u32 s[68:69], 0, v120
v_lshl_add_u32 v120, v126, 2, s100
s_mov_b64 exec, s[68:69]
ds_add_rtn_u32 v124, v120, v1
s_mov_b64 exec, -1
v_and_b32 v120, 2, v61
v_lshrrev_b32 v127, 24, v47
v_cmp_ne_u32 s[70:71], 0, v120
v_lshl_add_u32 v120, v127, 2, s100
s_mov_b64 exec, s[70:71]
ds_add_rtn_u32 v125, v120, v1
s_mov_b64 exec, -1
s_mov_b64 exec, s[36:37]
v_lshrrev_b32 v108, 9, v66
v_and_or_b32 v108, v108, s88, v80
v_cos_f32 v108, v108
s_nop 0
v_add_f32 v110, v108, v108
v_fma_f32 v109, v110, v108, -1.0
v_fma_f32 v110, v110, v109, -v108
v_cvt_pk_bf16_f32 v108, v108, v109
v_cvt_pk_bf16_f32 v109, v110, 0
v_cvt_pk_bf16_f32 v110, 0, v110
s_waitcnt lgkmcnt(2)
v_dot2_f32_bf16 v112, v106, v109, 0
v_dot2_f32_bf16 v113, v106, v110, 0
v_dot2_f32_bf16 v114, v107, v109, 0
v_dot2_f32_bf16 v115, v107, v110, 0
v_dot2_f32_bf16 v112, v102, v108, v112
v_dot2_f32_bf16 v113, v103, v108, v113
v_dot2_f32_bf16 v114, v104, v108, v114
v_dot2_f32_bf16 v115, v105, v108, v115
s_waitcnt vmcnt(9)
v_lshlrev_b32 v116, 16, v94
v_and_b32 v117, s91, v94
v_lshlrev_b32 v118, 16, v95
v_and_b32 v119, s91, v95
v_fma_f32 v116, v116, v112, v24
v_fma_f32 v117, v117, v113, v24
v_fma_f32 v118, v118, v114, v24
v_fma_f32 v119, v119, v115, v24
v_sub_co_u32 v116, vcc, v116, v24
v_sub_co_u32_e64 v118, s[72:73], v118, v24
s_nop 0
v_subb_co_u32 v117, vcc, v117, v24, vcc
v_subb_co_u32_e64 v119, s[72:73], v119, v24, s[72:73]
ds_add_u64 v111, v[116:117] offset:0
ds_add_u64 v111, v[118:119] offset:10000
s_mov_b64 exec, -1
s_waitcnt lgkmcnt(2)
v_cmp_gt_u32 vcc, 64, v124
v_lshl_add_u32 v120, v126, 6, v124
v_perm_b32 v64, v55, v46, s29
s_andn2_b64 s[66:67], s[68:69], vcc
s_and_b64 exec, s[68:69], vcc
v_lshl_add_u32 v120, v120, 2, s28
ds_write_b32 v120, v64
s_mov_b64 exec, -1
s_cmp_eq_u64 s[66:67], 0
s_cbranch_scc1 L_noovf_61
v_mov_b32 v63, v46
s_call_b64 s[98:99], L_k2_slow
L_noovf_61:
v_cmp_gt_u32 vcc, 64, v125
v_lshl_add_u32 v120, v127, 6, v125
v_perm_b32 v64, v55, v47, s31
s_andn2_b64 s[66:67], s[70:71], vcc
s_and_b64 exec, s[70:71], vcc
v_lshl_add_u32 v120, v120, 2, s28
ds_write_b32 v120, v64
s_mov_b64 exec, -1
s_cmp_eq_u64 s[66:67], 0
s_cbranch_scc1 L_noovf_62
v_mov_b32 v63, v47
s_call_b64 s[98:99], L_k2_slow
L_noovf_62:
s_mov_b64 exec, s[38:39]
v_lshrrev_b32 v111, 6, v67
v_and_b32 v111, 0x3ff8, v111
v_add_u32 v112, v111, v111
ds_read_b128 v[102:105], v112 offset:30048
ds_read_b64 v[106:107], v111 offset:20048
s_mov_b64 exec, -1
v_and_b32 v2, 0x1ff, v70
s_add_u32 s101, s90, 196608
s_mov_b64 exec, s[44:45]
buffer_load_dwordx2 v[94:95], v2, s[24:27], s101 idxen
s_mov_b64 exec, -1
s_waitcnt vmcnt(4)
v_and_b32 v120, 4, v61
v_lshrrev_b32 v126, 24, v48
v_cmp_ne_u32 s[68:69], 0, v120
v_lshl_add_u32 v120, v126, 2, s100
s_mov_b64 exec, s[68:69]
ds_add_rtn_u32 v124, v120, v1
s_mov_b64 exec, -1
v_and_b32 v120, 8, v61
v_lshrrev_b32 v127, 24, v49
v_cmp_ne_u32 s[70:71], 0, v120
v_lshl_add_u32 v120, v127, 2, s100
s_mov_b64 exec, s[70:71]
ds_add_rtn_u32 v125, v120, v1
s_mov_b64 exec, -1
s_mov_b64 exec, s[38:39]
v_lshrrev_b32 v108, 9, v67
v_and_or_b32 v108, v108, s88, v80
v_cos_f32 v108, v108
s_nop 0
v_add_f32 v110, v108, v108
v_fma_f32 v109, v110, v108, -1.0
v_fma_f32 v110, v110, v109, -v108
v_cvt_pk_bf16_f32 v108, v108, v109
v_cvt_pk_bf16_f32 v109, v110, 0
v_cvt_pk_bf16_f32 v110, 0, v110
s_waitcnt lgkmcnt(2)
v_dot2_f32_bf16 v112, v106, v109, 0
v_dot2_f32_bf16 v113, v106, v110, 0
v_dot2_f32_bf16 v114, v107, v109, 0
v_dot2_f32_bf16 v115, v107, v110, 0
v_dot2_f32_bf16 v112, v102, v108, v112
v_dot2_f32_bf16 v113, v103, v108, v113
v_dot2_f32_bf16 v114, v104, v108, v114
v_dot2_f32_bf16 v115, v105, v108, v115
s_waitcnt vmcnt(9)
v_lshlrev_b32 v116, 16, v96
v_and_b32 v117, s91, v96
v_lshlrev_b32 v118, 16, v97
v_and_b32 v119, s91, v97
v_fma_f32 v116, v116, v112, v24
v_fma_f32 v117, v117, v113, v24
v_fma_f32 v118, v118, v114, v24
v_fma_f32 v119, v119, v115, v24
v_sub_co_u32 v116, vcc, v116, v24
v_sub_co_u32_e64 v118, s[72:73], v118, v24
s_nop 0
v_subb_co_u32 v117, vcc, v117, v24, vcc
v_subb_co_u32_e64 v119, s[72:73], v119, v24, s[72:73]
ds_add_u64 v111, v[116:117] offset:0
ds_add_u64 v111, v[118:119] offset:10000
s_mov_b64 exec, -1
s_waitcnt lgkmcnt(2)
v_cmp_gt_u32 vcc, 64, v124
v_lshl_add_u32 v120, v126, 6, v124
v_perm_b32 v64, v55, v48, s15
s_andn2_b64 s[66:67], s[68:69], vcc
s_and_b64 exec, s[68:69], vcc
v_lshl_add_u32 v120, v120, 2, s28
ds_write_b32 v120, v64
s_mov_b64 exec, -1
s_cmp_eq_u64 s[66:67], 0
s_cbranch_scc1 L_noovf_63
v_mov_b32 v63, v48
s_call_b64 s[98:99], L_k2_slow
L_noovf_63:
v_cmp_gt_u32 vcc, 64, v125
v_lshl_add_u32 v120, v127, 6, v125
v_perm_b32 v64, v55, v49, s94
s_andn2_b64 s[66:67], s[70:71], vcc
s_and_b64 exec, s[70:71], vcc
v_lshl_add_u32 v120, v120, 2, s28
ds_write_b32 v120, v64
s_mov_b64 exec, -1
s_cmp_eq_u64 s[66:67], 0
s_cbranch_scc1 L_noovf_64
v_mov_b32 v63, v49
s_call_b64 s[98:99], L_k2_slow
L_noovf_64:
s_mov_b64 exec, s[40:41]
v_lshrrev_b32 v111, 6, v68
v_and_b32 v111, 0x3ff8, v111
v_add_u32 v112, v111, v111
ds_read_b128 v[102:105], v112 offset:30048
ds_read_b64 v[106:107], v111 offset:20048
s_mov_b64 exec, -1
v_and_b32 v2, 0x1ff, v71
s_add_u32 s101, s90, 245760
s_mov_b64 exec, s[46:47]
buffer_load_dwordx2 v[96:97], v2, s[24:27], s101 idxen
s_mov_b64 exec, -1
s_waitcnt vmcnt(3)
v_and_b32 v120, 1, v62
v_lshrrev_b32 v126, 24, v50
v_cmp_ne_u32 s[68:69], 0, v120
v_lshl_add_u32 v120, v126, 2, s100
s_mov_b64 exec, s[68:69]
ds_add_rtn_u32 v124, v120, v1
s_mov_b64 exec, -1
v_and_b32 v120, 2, v62
v_lshrrev_b32 v127, 24, v51
v_cmp_ne_u32 s[70:71], 0, v120
v_lshl_add_u32 v120, v127, 2, s100
s_mov_b64 exec, s[70:71]
ds_add_rtn_u32 v125, v120, v1
s_mov_b64 exec, -1
s_mov_b64 exec, s[40:41]
v_lshrrev_b32 v108, 9, v68
v_and_or_b32 v108, v108, s88, v80
v_cos_f32 v108, v108
s_nop 0
v_add_f32 v110, v108, v108
v_fma_f32 v109, v110, v108, -1.0
v_fma_f32 v110, v110, v109, -v108
v_cvt_pk_bf16_f32 v108, v108, v109
v_cvt_pk_bf16_f32 v109, v110, 0
v_cvt_pk_bf16_f32 v110, 0, v110
s_waitcnt lgkmcnt(2)
v_dot2_f32_bf16 v112, v106, v109, 0
v_dot2_f32_bf16 v113, v106, v110, 0
v_dot2_f32_bf16 v114, v107, v109, 0
v_dot2_f32_bf16 v115, v107, v110, 0
v_dot2_f32_bf16 v112, v102, v108, v112
v_dot2_f32_bf16 v113, v103, v108, v113
v_dot2_f32_bf16 v114, v104, v108, v114
v_dot2_f32_bf16 v115, v105, v108, v115
s_waitcnt vmcnt(9)
v_lshlrev_b32 v116, 16, v98
v_and_b32 v117, s91, v98
v_lshlrev_b32 v118, 16, v99
v_and_b32 v119, s91, v99
v_fma_f32 v116, v116, v112, v24
v_fma_f32 v117, v117, v113, v24
v_fma_f32 v118, v118, v114, v24
v_fma_f32 v119, v119, v115, v24
v_sub_co_u32 v116, vcc, v116, v24
v_sub_co_u32_e64 v118, s[72:73], v118, v24
s_nop 0
v_subb_co_u32 v117, vcc, v117, v24, vcc
v_subb_co_u32_e64 v119, s[72:73], v119, v24, s[72:73]
ds_add_u64 v111, v[116:117] offset:0
ds_add_u64 v111, v[118:119] offset:10000
s_mov_b64 exec, -1
s_setprio 1
s_waitcnt lgkmcnt(2)
v_cmp_gt_u32 vcc, 64, v124
v_lshl_add_u32 v120, v126, 6, v124
v_perm_b32 v64, v56, v50, s29
s_andn2_b64 s[66:67], s[68:69], vcc
s_and_b64 exec, s[68:69], vcc
v_lshl_add_u32 v120, v120, 2, s28
ds_write_b32 v120, v64
s_mov_b64 exec, -1
s_cmp_eq_u64 s[66:67], 0
s_cbranch_scc1 L_noovf_65
v_mov_b32 v63, v50
s_call_b64 s[98:99], L_k2_slow
L_noovf_65:
v_cmp_gt_u32 vcc, 64, v125
v_lshl_add_u32 v120, v127, 6, v125
v_perm_b32 v64, v56, v51, s31
s_andn2_b64 s[66:67], s[70:71], vcc
s_and_b64 exec, s[70:71], vcc
v_lshl_add_u32 v120, v120, 2, s28
ds_write_b32 v120, v64
s_mov_b64 exec, -1
s_cmp_eq_u64 s[66:67], 0
s_cbranch_scc1 L_noovf_66
v_mov_b32 v63, v51
s_call_b64 s[98:99], L_k2_slow
L_noovf_66:
s_mov_b64 exec, s[42:43]
v_lshrrev_b32 v111, 6, v69
v_and_b32 v111, 0x3ff8, v111
v_add_u32 v112, v111, v111
ds_read_b128 v[102:105], v112 offset:30048
ds_read_b64 v[106:107], v111 offset:20048
s_mov_b64 exec, -1
v_and_b32 v2, 0x1ff, v72
s_add_u32 s101, s90, 294912
s_mov_b64 exec, s[48:49]
buffer_load_dwordx2 v[98:99], v2, s[24:27], s101 idxen
s_mov_b64 exec, -1
s_waitcnt vmcnt(4)
v_and_b32 v120, 4, v62
v_lshrrev_b32 v126, 24, v52
v_cmp_ne_u32 s[68:69], 0, v120
v_lshl_add_u32 v120, v126, 2, s100
s_mov_b64 exec, s[68:69]
ds_add_rtn_u32 v124, v120, v1
s_mov_b64 exec, -1
v_and_b32 v120, 8, v62
v_lshrrev_b32 v127, 24, v53
v_cmp_ne_u32 s[70:71], 0, v120
v_lshl_add_u32 v120, v127, 2, s100
s_mov_b64 exec, s[70:71]
ds_add_rtn_u32 v125, v120, v1
s_mov_b64 exec, -1
s_mov_b64 exec, s[42:43]
v_lshrrev_b32 v108, 9, v69
v_and_or_b32 v108, v108, s88, v80
v_cos_f32 v108, v108
s_nop 0
v_add_f32 v110, v108, v108
v_fma_f32 v109, v110, v108, -1.0
v_fma_f32 v110, v110, v109, -v108
v_cvt_pk_bf16_f32 v108, v108, v109
v_cvt_pk_bf16_f32 v109, v110, 0
v_cvt_pk_bf16_f32 v110, 0, v110
s_waitcnt lgkmcnt(2)
v_dot2_f32_bf16 v112, v106, v109, 0
v_dot2_f32_bf16 v113, v106, v110, 0
v_dot2_f32_bf16 v114, v107, v109, 0
v_dot2_f32_bf16 v115, v107, v110, 0
v_dot2_f32_bf16 v112, v102, v108, v112
v_dot2_f32_bf16 v113, v103, v108, v113
v_dot2_f32_bf16 v114, v104, v108, v114
v_dot2_f32_bf16 v115, v105, v108, v115
s_waitcnt vmcnt(3)
v_lshlrev_b32 v116, 16, v100
v_and_b32 v117, s91, v100
v_lshlrev_b32 v118, 16, v101
v_and_b32 v119, s91, v101
v_fma_f32 v116, v116, v112, v24
v_fma_f32 v117, v117, v113, v24
v_fma_f32 v118, v118, v114, v24
v_fma_f32 v119, v119, v115, v24
v_sub_co_u32 v116, vcc, v116, v24
v_sub_co_u32_e64 v118, s[72:73], v118, v24
s_nop 0
v_subb_co_u32 v117, vcc, v117, v24, vcc
v_subb_co_u32_e64 v119, s[72:73], v119, v24, s[72:73]
ds_add_u64 v111, v[116:117] offset:0
ds_add_u64 v111, v[118:119] offset:10000
s_mov_b64 exec, -1
s_waitcnt lgkmcnt(2)
v_cmp_gt_u32 vcc, 64, v124
v_lshl_add_u32 v120, v126, 6, v124
v_perm_b32 v64, v56, v52, s15
s_andn2_b64 s[66:67], s[68:69], vcc
s_and_b64 exec, s[68:69], vcc
v_lshl_add_u32 v120, v120, 2, s28
ds_write_b32 v120, v64
s_mov_b64 exec, -1
s_cmp_eq_u64 s[66:67], 0
s_cbranch_scc1 L_noovf_67
v_mov_b32 v63, v52
s_call_b64 s[98:99], L_k2_slow
L_noovf_67:
v_cmp_gt_u32 vcc, 64, v125
v_lshl_add_u32 v120, v127, 6, v125
v_perm_b32 v64, v56, v53, s94
s_andn2_b64 s[66:67], s[70:71], vcc
s_and_b64 exec, s[70:71], vcc
v_lshl_add_u32 v120, v120, 2, s28
ds_write_b32 v120, v64
s_mov_b64 exec, -1
s_cmp_eq_u64 s[66:67], 0
s_cbranch_scc1 L_noovf_68
v_mov_b32 v63, v53
s_call_b64 s[98:99], L_k2_slow
L_noovf_68:
s_mov_b64 exec, 1
ds_add_u32 v25, v1 offset:20036
s_mov_b64 exec, -1
s_mov_b64 exec, s[44:45]
v_lshrrev_b32 v111, 6, v70
v_and_b32 v111, 0x3ff8, v111
v_add_u32 v112, v111, v111
ds_read_b128 v[102:105], v112 offset:30048
ds_read_b64 v[106:107], v111 offset:20048
s_mov_b64 exec, -1
v_and_b32 v2, 0x1ff, v73
s_add_u32 s101, s90, 344064
s_mov_b64 exec, s[50:51]
buffer_load_dwordx2 v[100:101], v2, s[24:27], s101 idxen
s_mov_b64 exec, -1
s_mov_b64 exec, s[44:45]
v_lshrrev_b32 v108, 9, v70
v_and_or_b32 v108, v108, s88, v80
v_cos_f32 v108, v108
s_nop 0
v_add_f32 v110, v108, v108
v_fma_f32 v109, v110, v108, -1.0
v_fma_f32 v110, v110, v109, -v108
v_cvt_pk_bf16_f32 v108, v108, v109
v_cvt_pk_bf16_f32 v109, v110, 0
v_cvt_pk_bf16_f32 v110, 0, v110
s_waitcnt lgkmcnt(0)
v_dot2_f32_bf16 v112, v106, v109, 0
v_dot2_f32_bf16 v113, v106, v110, 0
v_dot2_f32_bf16 v114, v107, v109, 0
v_dot2_f32_bf16 v115, v107, v110, 0
v_dot2_f32_bf16 v112, v102, v108, v112
v_dot2_f32_bf16 v113, v103, v108, v113
v_dot2_f32_bf16 v114, v104, v108, v114
v_dot2_f32_bf16 v115, v105, v108, v115
s_waitcnt vmcnt(3)
v_lshlrev_b32 v116, 16, v94
v_and_b32 v117, s91, v94
v_lshlrev_b32 v118, 16, v95
v_and_b32 v119, s91, v95
v_fma_f32 v116, v116, v112, v24
v_fma_f32 v117, v117, v113, v24
v_fma_f32 v118, v118, v114, v24
v_fma_f32 v119, v119, v115, v24
v_sub_co_u32 v116, vcc, v116, v24
v_sub_co_u32_e64 v118, s[72:73], v118, v24
s_nop 0
v_subb_co_u32 v117, vcc, v117, v24, vcc
v_subb_co_u32_e64 v119, s[72:73], v119, v24, s[72:73]
ds_add_u64 v111, v[116:117] offset:0
ds_add_u64 v111, v[118:119] offset:10000
s_mov_b64 exec, -1
s_mov_b64 exec, s[46:47]
v_lshrrev_b32 v111, 6, v71
v_and_b32 v111, 0x3ff8, v111
v_add_u32 v112, v111, v111
ds_read_b128 v[102:105], v112 offset:30048
ds_read_b64 v[106:107], v111 offset:20048
s_mov_b64 exec, -1
v_and_b32 v2, 0x1ff, v74
s_add_u32 s101, s90, 393216
s_mov_b64 exec, s[52:53]
buffer_load_dwordx2 v[94:95], v2, s[24:27], s101 idxen
s_mov_b64 exec, -1
s_mov_b64 exec, s[46:47]
v_lshrrev_b32 v108, 9, v71
v_and_or_b32 v108, v108, s88, v80
v_cos_f32 v108, v108
s_nop 0
v_add_f32 v110, v108, v108
v_fma_f32 v109, v110, v108, -1.0
v_fma_f32 v110, v110, v109, -v108
v_cvt_pk_bf16_f32 v108, v108, v109
v_cvt_pk_bf16_f32 v109, v110, 0
v_cvt_pk_bf16_f32 v110, 0, v110
s_waitcnt lgkmcnt(0)
v_dot2_f32_bf16 v112, v106, v109, 0
v_dot2_f32_bf16 v113, v106, v110, 0
v_dot2_f32_bf16 v114, v107, v109, 0
v_dot2_f32_bf16 v115, v107, v110, 0
v_dot2_f32_bf16 v112, v102, v108, v112
v_dot2_f32_bf16 v113, v103, v108, v113
v_dot2_f32_bf16 v114, v104, v108, v114
v_dot2_f32_bf16 v115, v105, v108, v115
s_waitcnt vmcnt(3)
v_lshlrev_b32 v116, 16, v96
v_and_b32 v117, s91, v96
v_lshlrev_b32 v118, 16, v97
v_and_b32 v119, s91, v97
v_fma_f32 v116, v116, v112, v24
v_fma_f32 v117, v117, v113, v24
v_fma_f32 v118, v118, v114, v24
v_fma_f32 v119, v119, v115, v24
v_sub_co_u32 v116, vcc, v116, v24
v_sub_co_u32_e64 v118, s[72:73], v118, v24
s_nop 0
v_subb_co_u32 v117, vcc, v117, v24, vcc
v_subb_co_u32_e64 v119, s[72:73], v119, v24, s[72:73]
ds_add_u64 v111, v[116:117] offset:0
ds_add_u64 v111, v[118:119] offset:10000
s_mov_b64 exec, -1
s_mov_b64 exec, s[48:49]
v_lshrrev_b32 v111, 6, v72
v_and_b32 v111, 0x3ff8, v111
v_add_u32 v112, v111, v111
ds_read_b128 v[102:105], v112 offset:30048
ds_read_b64 v[106:107], v111 offset:20048
s_mov_b64 exec, -1
v_and_b32 v2, 0x1ff, v75
s_add_u32 s101, s90, 442368
s_mov_b64 exec, s[54:55]
buffer_load_dwordx2 v[96:97], v2, s[24:27], s101 idxen
s_mov_b64 exec, -1
s_mov_b64 exec, s[48:49]
v_lshrrev_b32 v108, 9, v72
v_and_or_b32 v108, v108, s88, v80
v_cos_f32 v108, v108
s_nop 0
v_add_f32 v110, v108, v108
v_fma_f32 v109, v110, v108, -1.0
v_fma_f32 v110, v110, v109, -v108
v_cvt_pk_bf16_f32 v108, v108, v109
v_cvt_pk_bf16_f32 v109, v110, 0
v_cvt_pk_bf16_f32 v110, 0, v110
s_waitcnt lgkmcnt(0)
v_dot2_f32_bf16 v112, v106, v109, 0
v_dot2_f32_bf16 v113, v106, v110, 0
v_dot2_f32_bf16 v114, v107, v109, 0
v_dot2_f32_bf16 v115, v107, v110, 0
v_dot2_f32_bf16 v112, v102, v108, v112
v_dot2_f32_bf16 v113, v103, v108, v113
v_dot2_f32_bf16 v114, v104, v108, v114
v_dot2_f32_bf16 v115, v105, v108, v115
s_waitcnt vmcnt(3)
v_lshlrev_b32 v116, 16, v98
v_and_b32 v117, s91, v98
v_lshlrev_b32 v118, 16, v99
v_and_b32 v119, s91, v99
v_fma_f32 v116, v116, v112, v24
v_fma_f32 v117, v117, v113, v24
v_fma_f32 v118, v118, v114, v24
v_fma_f32 v119, v119, v115, v24
v_sub_co_u32 v116, vcc, v116, v24
v_sub_co_u32_e64 v118, s[72:73], v118, v24
s_nop 0
v_subb_co_u32 v117, vcc, v117, v24, vcc
v_subb_co_u32_e64 v119, s[72:73], v119, v24, s[72:73]
ds_add_u64 v111, v[116:117] offset:0
ds_add_u64 v111, v[118:119] offset:10000
s_mov_b64 exec, -1
s_setprio 0
s_mov_b64 exec, s[50:51]
v_lshrrev_b32 v111, 6, v73
v_and_b32 v111, 0x3ff8, v111
v_add_u32 v112, v111, v111
ds_read_b128 v[102:105], v112 offset:30048
ds_read_b64 v[106:107], v111 offset:20048
s_mov_b64 exec, -1
v_and_b32 v2, 0x1ff, v76
s_add_u32 s101, s90, 491520
s_mov_b64 exec, s[56:57]
buffer_load_dwordx2 v[98:99], v2, s[24:27], s101 idxen
s_mov_b64 exec, -1
s_mov_b64 exec, s[50:51]
v_lshrrev_b32 v108, 9, v73
v_and_or_b32 v108, v108, s88, v80
v_cos_f32 v108, v108
s_nop 0
v_add_f32 v110, v108, v108
v_fma_f32 v109, v110, v108, -1.0
v_fma_f32 v110, v110, v109, -v108
v_cvt_pk_bf16_f32 v108, v108, v109
v_cvt_pk_bf16_f32 v109, v110, 0
v_cvt_pk_bf16_f32 v110, 0, v110
s_waitcnt lgkmcnt(0)
v_dot2_f32_bf16 v112, v106, v109, 0
v_dot2_f32_bf16 v113, v106, v110, 0
v_dot2_f32_bf16 v114, v107, v109, 0
v_dot2_f32_bf16 v115, v107, v110, 0
v_dot2_f32_bf16 v112, v102, v108, v112
v_dot2_f32_bf16 v113, v103, v108, v113
v_dot2_f32_bf16 v114, v104, v108, v114
v_dot2_f32_bf16 v115, v105, v108, v115
s_waitcnt vmcnt(3)
v_lshlrev_b32 v116, 16, v100
v_and_b32 v117, s91, v100
v_lshlrev_b32 v118, 16, v101
v_and_b32 v119, s91, v101
v_fma_f32 v116, v116, v112, v24
v_fma_f32 v117, v117, v113, v24
v_fma_f32 v118, v118, v114, v24
v_fma_f32 v119, v119, v115, v24
v_sub_co_u32 v116, vcc, v116, v24
v_sub_co_u32_e64 v118, s[72:73], v118, v24
s_nop 0
v_subb_co_u32 v117, vcc, v117, v24, vcc
v_subb_co_u32_e64 v119, s[72:73], v119, v24, s[72:73]
ds_add_u64 v111, v[116:117] offset:0
ds_add_u64 v111, v[118:119] offset:10000
s_mov_b64 exec, -1
s_mov_b64 exec, s[52:53]
v_lshrrev_b32 v111, 6, v74
v_and_b32 v111, 0x3ff8, v111
v_add_u32 v112, v111, v111
ds_read_b128 v[102:105], v112 offset:30048
ds_read_b64 v[106:107], v111 offset:20048
s_mov_b64 exec, -1
v_and_b32 v2, 0x1ff, v77
s_add_u32 s101, s90, 540672
s_mov_b64 exec, s[58:59]
buffer_load_dwordx2 v[100:101], v2, s[24:27], s101 idxen
s_mov_b64 exec, -1
s_mov_b64 exec, s[52:53]
v_lshrrev_b32 v108, 9, v74
v_and_or_b32 v108, v108, s88, v80
v_cos_f32 v108, v108
s_nop 0
v_add_f32 v110, v108, v108
v_fma_f32 v109, v110, v108, -1.0
v_fma_f32 v110, v110, v109, -v108
v_cvt_pk_bf16_f32 v108, v108, v109
v_cvt_pk_bf16_f32 v109, v110, 0
v_cvt_pk_bf16_f32 v110, 0, v110
s_waitcnt lgkmcnt(0)
v_dot2_f32_bf16 v112, v106, v109, 0
v_dot2_f32_bf16 v113, v106, v110, 0
v_dot2_f32_bf16 v114, v107, v109, 0
v_dot2_f32_bf16 v115, v107, v110, 0
v_dot2_f32_bf16 v112, v102, v108, v112
v_dot2_f32_bf16 v113, v103, v108, v113
v_dot2_f32_bf16 v114, v104, v108, v114
v_dot2_f32_bf16 v115, v105, v108, v115
s_waitcnt vmcnt(3)
v_lshlrev_b32 v116, 16, v94
v_and_b32 v117, s91, v94
v_lshlrev_b32 v118, 16, v95
v_and_b32 v119, s91, v95
v_fma_f32 v116, v116, v112, v24
v_fma_f32 v117, v117, v113, v24
v_fma_f32 v118, v118, v114, v24
v_fma_f32 v119, v119, v115, v24
v_sub_co_u32 v116, vcc, v116, v24
v_sub_co_u32_e64 v118, s[72:73], v118, v24
s_nop 0
v_subb_co_u32 v117, vcc, v117, v24, vcc
v_subb_co_u32_e64 v119, s[72:73], v119, v24, s[72:73]
ds_add_u64 v111, v[116:117] offset:0
ds_add_u64 v111, v[118:119] offset:10000
s_mov_b64 exec, -1
s_mov_b64 exec, s[54:55]
v_lshrrev_b32 v111, 6, v75
v_and_b32 v111, 0x3ff8, v111
v_add_u32 v112, v111, v111
ds_read_b128 v[102:105], v112 offset:30048
ds_read_b64 v[106:107], v111 offset:20048
s_mov_b64 exec, -1
v_and_b32 v2, 0x1ff, v78
s_add_u32 s101, s90, 589824
s_mov_b64 exec, s[60:61]
buffer_load_dwordx2 v[94:95], v2, s[24:27], s101 idxen
s_mov_b64 exec, -1
s_mov_b64 exec, s[54:55]
v_lshrrev_b32 v108, 9, v75
v_and_or_b32 v108, v108, s88, v80
v_cos_f32 v108, v108
s_nop 0
v_add_f32 v110, v108, v108
v_fma_f32 v109, v110, v108, -1.0
v_fma_f32 v110, v110, v109, -v108
v_cvt_pk_bf16_f32 v108, v108, v109
v_cvt_pk_bf16_f32 v109, v110, 0
v_cvt_pk_bf16_f32 v110, 0, v110
s_waitcnt lgkmcnt(0)
v_dot2_f32_bf16 v112, v106, v109, 0
v_dot2_f32_bf16 v113, v106, v110, 0
v_dot2_f32_bf16 v114, v107, v109, 0
v_dot2_f32_bf16 v115, v107, v110, 0
v_dot2_f32_bf16 v112, v102, v108, v112
v_dot2_f32_bf16 v113, v103, v108, v113
v_dot2_f32_bf16 v114, v104, v108, v114
v_dot2_f32_bf16 v115, v105, v108, v115
s_waitcnt vmcnt(3)
v_lshlrev_b32 v116, 16, v96
v_and_b32 v117, s91, v96
v_lshlrev_b32 v118, 16, v97
v_and_b32 v119, s91, v97
v_fma_f32 v116, v116, v112, v24
v_fma_f32 v117, v117, v113, v24
v_fma_f32 v118, v118, v114, v24
v_fma_f32 v119, v119, v115, v24
v_sub_co_u32 v116, vcc, v116, v24
v_sub_co_u32_e64 v118, s[72:73], v118, v24
s_nop 0
v_subb_co_u32 v117, vcc, v117, v24, vcc
v_subb_co_u32_e64 v119, s[72:73], v119, v24, s[72:73]
ds_add_u64 v111, v[116:117] offset:0
ds_add_u64 v111, v[118:119] offset:10000
s_mov_b64 exec, -1
s_mov_b64 exec, s[56:57]
v_lshrrev_b32 v111, 6, v76
v_and_b32 v111, 0x3ff8, v111
v_add_u32 v112, v111, v111
ds_read_b128 v[102:105], v112 offset:30048
ds_read_b64 v[106:107], v111 offset:20048
s_mov_b64 exec, -1
v_and_b32 v2, 0x1ff, v79
s_add_u32 s101, s90, 638976
s_mov_b64 exec, s[62:63]
buffer_load_dwordx2 v[96:97], v2, s[24:27], s101 idxen
s_mov_b64 exec, -1
s_mov_b64 exec, s[56:57]
v_lshrrev_b32 v108, 9, v76
v_and_or_b32 v108, v108, s88, v80
v_cos_f32 v108, v108
s_nop 0
v_add_f32 v110, v108, v108
v_fma_f32 v109, v110, v108, -1.0
v_fma_f32 v110, v110, v109, -v108
v_cvt_pk_bf16_f32 v108, v108, v109
v_cvt_pk_bf16_f32 v109, v110, 0
v_cvt_pk_bf16_f32 v110, 0, v110
s_waitcnt lgkmcnt(0)
v_dot2_f32_bf16 v112, v106, v109, 0
v_dot2_f32_bf16 v113, v106, v110, 0
v_dot2_f32_bf16 v114, v107, v109, 0
v_dot2_f32_bf16 v115, v107, v110, 0
v_dot2_f32_bf16 v112, v102, v108, v112
v_dot2_f32_bf16 v113, v103, v108, v113
v_dot2_f32_bf16 v114, v104, v108, v114
v_dot2_f32_bf16 v115, v105, v108, v115
s_waitcnt vmcnt(3)
v_lshlrev_b32 v116, 16, v98
v_and_b32 v117, s91, v98
v_lshlrev_b32 v118, 16, v99
v_and_b32 v119, s91, v99
v_fma_f32 v116, v116, v112, v24
v_fma_f32 v117, v117, v113, v24
v_fma_f32 v118, v118, v114, v24
v_fma_f32 v119, v119, v115, v24
v_sub_co_u32 v116, vcc, v116, v24
v_sub_co_u32_e64 v118, s[72:73], v118, v24
s_nop 0
v_subb_co_u32 v117, vcc, v117, v24, vcc
v_subb_co_u32_e64 v119, s[72:73], v119, v24, s[72:73]
ds_add_u64 v111, v[116:117] offset:0
ds_add_u64 v111, v[118:119] offset:10000
s_mov_b64 exec, -1
s_mov_b64 exec, s[58:59]
v_lshrrev_b32 v111, 6, v77
v_and_b32 v111, 0x3ff8, v111
v_add_u32 v112, v111, v111
ds_read_b128 v[102:105], v112 offset:30048
ds_read_b64 v[106:107], v111 offset:20048
s_mov_b64 exec, -1
s_mov_b64 exec, s[58:59]
v_lshrrev_b32 v108, 9, v77
v_and_or_b32 v108, v108, s88, v80
v_cos_f32 v108, v108
s_nop 0
v_add_f32 v110, v108, v108
v_fma_f32 v109, v110, v108, -1.0
v_fma_f32 v110, v110, v109, -v108
v_cvt_pk_bf16_f32 v108, v108, v109
v_cvt_pk_bf16_f32 v109, v110, 0
v_cvt_pk_bf16_f32 v110, 0, v110
s_waitcnt lgkmcnt(0)
v_dot2_f32_bf16 v112, v106, v109, 0
v_dot2_f32_bf16 v113, v106, v110, 0
v_dot2_f32_bf16 v114, v107, v109, 0
v_dot2_f32_bf16 v115, v107, v110, 0
v_dot2_f32_bf16 v112, v102, v108, v112
v_dot2_f32_bf16 v113, v103, v108, v113
v_dot2_f32_bf16 v114, v104, v108, v114
v_dot2_f32_bf16 v115, v105, v108, v115
s_waitcnt vmcnt(2)
v_lshlrev_b32 v116, 16, v100
v_and_b32 v117, s91, v100
v_lshlrev_b32 v118, 16, v101
v_and_b32 v119, s91, v101
v_fma_f32 v116, v116, v112, v24
v_fma_f32 v117, v117, v113, v24
v_fma_f32 v118, v118, v114, v24
v_fma_f32 v119, v119, v115, v24
v_sub_co_u32 v116, vcc, v116, v24
v_sub_co_u32_e64 v118, s[72:73], v118, v24
s_nop 0
v_subb_co_u32 v117, vcc, v117, v24, vcc
v_subb_co_u32_e64 v119, s[72:73], v119, v24, s[72:73]
ds_add_u64 v111, v[116:117] offset:0
ds_add_u64 v111, v[118:119] offset:10000
s_mov_b64 exec, -1
s_mov_b64 exec, s[60:61]
v_lshrrev_b32 v111, 6, v78
v_and_b32 v111, 0x3ff8, v111
v_add_u32 v112, v111, v111
ds_read_b128 v[102:105], v112 offset:30048
ds_read_b64 v[106:107], v111 offset:20048
s_mov_b64 exec, -1
s_mov_b64 exec, s[60:61]
v_lshrrev_b32 v108, 9, v78
v_and_or_b32 v108, v108, s88, v80
v_cos_f32 v108, v108
s_nop 0
v_add_f32 v110, v108, v108
v_fma_f32 v109, v110, v108, -1.0
v_fma_f32 v110, v110, v109, -v108
v_cvt_pk_bf16_f32 v108, v108, v109
v_cvt_pk_bf16_f32 v109, v110, 0
v_cvt_pk_bf16_f32 v110, 0, v110
s_waitcnt lgkmcnt(0)
v_dot2_f32_bf16 v112, v106, v109, 0
v_dot2_f32_bf16 v113, v106, v110, 0
v_dot2_f32_bf16 v114, v107, v109, 0
v_dot2_f32_bf16 v115, v107, v110, 0
v_dot2_f32_bf16 v112, v102, v108, v112
v_dot2_f32_bf16 v113, v103, v108, v113
v_dot2_f32_bf16 v114, v104, v108, v114
v_dot2_f32_bf16 v115, v105, v108, v115
s_waitcnt vmcnt(1)
v_lshlrev_b32 v116, 16, v94
v_and_b32 v117, s91, v94
v_lshlrev_b32 v118, 16, v95
v_and_b32 v119, s91, v95
v_fma_f32 v116, v116, v112, v24
v_fma_f32 v117, v117, v113, v24
v_fma_f32 v118, v118, v114, v24
v_fma_f32 v119, v119, v115, v24
v_sub_co_u32 v116, vcc, v116, v24
v_sub_co_u32_e64 v118, s[72:73], v118, v24
s_nop 0
v_subb_co_u32 v117, vcc, v117, v24, vcc
v_subb_co_u32_e64 v119, s[72:73], v119, v24, s[72:73]
ds_add_u64 v111, v[116:117] offset:0
ds_add_u64 v111, v[118:119] offset:10000
s_mov_b64 exec, -1
s_mov_b64 exec, s[62:63]
v_lshrrev_b32 v111, 6, v79
v_and_b32 v111, 0x3ff8, v111
v_add_u32 v112, v111, v111
ds_read_b128 v[102:105], v112 offset:30048
ds_read_b64 v[106:107], v111 offset:20048
s_mov_b64 exec, -1
s_mov_b64 exec, s[62:63]
v_lshrrev_b32 v108, 9, v79
v_and_or_b32 v108, v108, s88, v80
v_cos_f32 v108, v108
s_nop 0
v_add_f32 v110, v108, v108
v_fma_f32 v109, v110, v108, -1.0
v_fma_f32 v110, v110, v109, -v108
v_cvt_pk_bf16_f32 v108, v108, v109
v_cvt_pk_bf16_f32 v109, v110, 0
v_cvt_pk_bf16_f32 v110, 0, v110
s_waitcnt lgkmcnt(0)
v_dot2_f32_bf16 v112, v106, v109, 0
v_dot2_f32_bf16 v113, v106, v110, 0
v_dot2_f32_bf16 v114, v107, v109, 0
v_dot2_f32_bf16 v115, v107, v110, 0
v_dot2_f32_bf16 v112, v102, v108, v112
v_dot2_f32_bf16 v113, v103, v108, v113
v_dot2_f32_bf16 v114, v104, v108, v114
v_dot2_f32_bf16 v115, v105, v108, v115
s_waitcnt vmcnt(0)
v_lshlrev_b32 v116, 16, v96
v_and_b32 v117, s91, v96
v_lshlrev_b32 v118, 16, v97
v_and_b32 v119, s91, v97
v_fma_f32 v116, v116, v112, v24
v_fma_f32 v117, v117, v113, v24
v_fma_f32 v118, v118, v114, v24
v_fma_f32 v119, v119, v115, v24
v_sub_co_u32 v116, vcc, v116, v24
v_sub_co_u32_e64 v118, s[72:73], v118, v24
s_nop 0
v_subb_co_u32 v117, vcc, v117, v24, vcc
v_subb_co_u32_e64 v119, s[72:73], v119, v24, s[72:73]
ds_add_u64 v111, v[116:117] offset:0
ds_add_u64 v111, v[118:119] offset:10000
s_mov_b64 exec, -1
s_add_u32 s65, s65, 1
s_cmp_eq_u32 s92, 0
s_cbranch_scc1 L_k2_done
s_cmp_lt_u32 s65, 4
s_cbranch_scc1 L_noflush_69
s_waitcnt vmcnt(0) lgkmcnt(0)
s_barrier
v_lshlrev_b32 v2, 3, v0
v_mov_b32 v8, 0
v_mov_b32 v9, 0
ds_read_b64 v[4:5], v2 offset:0
ds_read_b64 v[6:7], v2 offset:10000
s_waitcnt lgkmcnt(0)
ds_write_b64 v2, v[8:9] offset:0
ds_write_b64 v2, v[8:9] offset:10000
v_lshrrev_b32 v3, 31, v4
v_add_u32 v5, v5, v3
v_lshrrev_b32 v3, 31, v6
v_add_u32 v7, v7, v3
v_cvt_f32_i32 v4, v4
v_add_f32 v28, v28, v4
v_cvt_f32_i32 v5, v5
v_add_f32 v29, v29, v5
v_cvt_f32_i32 v6, v6
v_add_f32 v30, v30, v6
v_cvt_f32_i32 v7, v7
v_add_f32 v31, v31, v7
v_cmp_gt_u32 vcc, 226, v0
s_and_saveexec_b64 s[96:97], vcc
ds_read_b64 v[4:5], v2 offset:8192
ds_read_b64 v[6:7], v2 offset:18192
s_waitcnt lgkmcnt(0)
ds_write_b64 v2, v[8:9] offset:8192
ds_write_b64 v2, v[8:9] offset:18192
v_lshrrev_b32 v3, 31, v4
v_add_u32 v5, v5, v3
v_lshrrev_b32 v3, 31, v6
v_add_u32 v7, v7, v3
v_cvt_f32_i32 v4, v4
v_add_f32 v32, v32, v4
v_cvt_f32_i32 v5, v5
v_add_f32 v33, v33, v5
v_cvt_f32_i32 v6, v6
v_add_f32 v34, v34, v6
v_cvt_f32_i32 v7, v7
v_add_f32 v35, v35, v7
s_mov_b64 exec, s[96:97]
s_waitcnt lgkmcnt(0)
s_barrier
s_mov_b32 s65, 0
L_noflush_69:
s_branch L_k2_batch
L_k2_slow:
s_mov_b64 exec, s[66:67]
v_lshrrev_b32 v2, 24, v63
v_add_u32 v2, s93, v2
v_and_b32 v3, 0x1ff, v63
v_mul_u32_u24 v2, 384, v2
v_add_u32 v2, v2, v3
buffer_load_dwordx2 v[122:123], v2, s[24:27], 0 idxen
v_lshrrev_b32 v111, 6, v63
v_and_b32 v111, 0x3ff8, v111
v_add_u32 v112, v111, v111
ds_read_b128 v[102:105], v112 offset:30048
ds_read_b64 v[106:107], v111 offset:20048
v_lshrrev_b32 v108, 9, v64
v_and_or_b32 v108, v108, s88, v80
v_cos_f32 v108, v108
s_nop 0
v_add_f32 v110, v108, v108
v_fma_f32 v109, v110, v108, -1.0
v_fma_f32 v110, v110, v109, -v108
v_cvt_pk_bf16_f32 v108, v108, v109
v_cvt_pk_bf16_f32 v109, v110, 0
v_cvt_pk_bf16_f32 v110, 0, v110
s_waitcnt lgkmcnt(0)
v_dot2_f32_bf16 v112, v106, v109, 0
v_dot2_f32_bf16 v113, v106, v110, 0
v_dot2_f32_bf16 v114, v107, v109, 0
v_dot2_f32_bf16 v115, v107, v110, 0
v_dot2_f32_bf16 v112, v102, v108, v112
v_dot2_f32_bf16 v113, v103, v108, v113
v_dot2_f32_bf16 v114, v104, v108, v114
v_dot2_f32_bf16 v115, v105, v108, v115
s_waitcnt vmcnt(0)
v_lshlrev_b32 v116, 16, v122
v_and_b32 v117, s91, v122
v_lshlrev_b32 v118, 16, v123
v_and_b32 v119, s91, v123
v_fma_f32 v116, v116, v112, v24
v_fma_f32 v117, v117, v113, v24
v_fma_f32 v118, v118, v114, v24
v_fma_f32 v119, v119, v115, v24
v_sub_co_u32 v116, vcc, v116, v24
v_sub_co_u32_e64 v118, s[72:73], v118, v24
s_nop 0
v_subb_co_u32 v117, vcc, v117, v24, vcc
v_subb_co_u32_e64 v119, s[72:73], v119, v24, s[72:73]
ds_add_u64 v111, v[116:117] offset:0
ds_add_u64 v111, v[118:119] offset:10000
s_waitcnt lgkmcnt(0)
s_mov_b64 exec, -1
s_setpc_b64 s[98:99]
L_k2_done:
s_waitcnt vmcnt(0) lgkmcnt(0)
s_barrier
v_lshlrev_b32 v2, 3, v0
v_mov_b32 v8, 0
v_mov_b32 v9, 0
ds_read_b64 v[4:5], v2 offset:0
ds_read_b64 v[6:7], v2 offset:10000
s_waitcnt lgkmcnt(0)
ds_write_b64 v2, v[8:9] offset:0
ds_write_b64 v2, v[8:9] offset:10000
v_lshrrev_b32 v3, 31, v4
v_add_u32 v5, v5, v3
v_lshrrev_b32 v3, 31, v6
v_add_u32 v7, v7, v3
v_cvt_f32_i32 v4, v4
v_add_f32 v28, v28, v4
v_cvt_f32_i32 v5, v5
v_add_f32 v29, v29, v5
v_cvt_f32_i32 v6, v6
v_add_f32 v30, v30, v6
v_cvt_f32_i32 v7, v7
v_add_f32 v31, v31, v7
v_cmp_gt_u32 vcc, 226, v0
s_and_saveexec_b64 s[96:97], vcc
ds_read_b64 v[4:5], v2 offset:8192
ds_read_b64 v[6:7], v2 offset:18192
s_waitcnt lgkmcnt(0)
ds_write_b64 v2, v[8:9] offset:8192
ds_write_b64 v2, v[8:9] offset:18192
v_lshrrev_b32 v3, 31, v4
v_add_u32 v5, v5, v3
v_lshrrev_b32 v3, 31, v6
v_add_u32 v7, v7, v3
v_cvt_f32_i32 v4, v4
v_add_f32 v32, v32, v4
v_cvt_f32_i32 v5, v5
v_add_f32 v33, v33, v5
v_cvt_f32_i32 v6, v6
v_add_f32 v34, v34, v6
v_cvt_f32_i32 v7, v7
v_add_f32 v35, v35, v7
s_mov_b64 exec, s[96:97]
s_waitcnt lgkmcnt(0)
s_load_dwordx8 s[56:63], s[16:17], 0
s_mov_b32 s20, s4
s_and_b32 s21, s5, 0xffff
s_mov_b32 s22, 2560000
s_mov_b32 s23, 0x20000
s_mov_b32 s24, s18
s_and_b32 s25, s19, 0xffff
s_mov_b32 s26, 2560000
s_mov_b32 s27, 0x20000
s_mul_i32 s97, s2, 1250
v_add_u32 v3, s97, v0
v_lshlrev_b32 v3, 3, v3
v_add_u32 v4, 8192, v3
buffer_load_dwordx2 v[66:67], v3, s[20:23], 0 offen
buffer_load_dwordx2 v[68:69], v4, s[20:23], 0 offen
s_waitcnt lgkmcnt(0)
s_lshl_b32 s36, s56, 16
s_and_b32 s37, s56, s91
s_lshl_b32 s38, s57, 16
s_and_b32 s39, s57, s91
s_lshl_b32 s40, s58, 16
s_and_b32 s41, s58, s91
s_lshl_b32 s42, s59, 16
s_and_b32 s43, s59, s91
s_lshl_b32 s44, s60, 16
s_and_b32 s45, s60, s91
s_lshl_b32 s46, s61, 16
s_and_b32 s47, s61, s91
s_lshl_b32 s48, s62, 16
s_and_b32 s49, s62, s91
s_lshl_b32 s50, s63, 16
s_and_b32 s51, s63, s91
v_bfe_u32 v9, v40, 0, 8
v_sub_u32 v9, 254, v9
v_lshlrev_b32 v9, 23, v9
v_mul_f32 v100, v28, v9
v_bfe_u32 v9, v40, 8, 8
v_sub_u32 v9, 254, v9
v_lshlrev_b32 v9, 23, v9
v_mul_f32 v101, v29, v9
v_bfe_u32 v9, v40, 16, 8
v_sub_u32 v9, 254, v9
v_lshlrev_b32 v9, 23, v9
v_mul_f32 v102, v30, v9
v_bfe_u32 v9, v40, 24, 8
v_sub_u32 v9, 254, v9
v_lshlrev_b32 v9, 23, v9
v_mul_f32 v103, v31, v9
v_cvt_pk_bf16_f32 v9, v100, v101
v_lshlrev_b32 v100, 16, v9
v_and_b32 v101, s91, v9
v_cvt_pk_bf16_f32 v9, v102, v103
v_lshlrev_b32 v102, 16, v9
v_and_b32 v103, s91, v9
v_mul_f32 v104, s36, v100
v_fmac_f32 v104, s40, v101
v_fmac_f32 v104, s44, v102
v_fmac_f32 v104, s48, v103
v_mul_f32 v105, s37, v100
v_fmac_f32 v105, s41, v101
v_fmac_f32 v105, s45, v102
v_fmac_f32 v105, s49, v103
v_mul_f32 v106, s38, v100
v_fmac_f32 v106, s42, v101
v_fmac_f32 v106, s46, v102
v_fmac_f32 v106, s50, v103
v_mul_f32 v107, s39, v100
v_fmac_f32 v107, s43, v101
v_fmac_f32 v107, s47, v102
v_fmac_f32 v107, s51, v103
v_cvt_pk_bf16_f32 v9, v104, v105
v_lshlrev_b32 v104, 16, v9
v_and_b32 v105, s91, v9
v_cvt_pk_bf16_f32 v9, v106, v107
v_lshlrev_b32 v106, 16, v9
v_and_b32 v107, s91, v9
v_lshlrev_b32 v100, 16, v36
v_and_b32 v101, s91, v36
v_lshlrev_b32 v102, 16, v37
v_and_b32 v103, s91, v37
v_mul_f32 v104, v104, v100
v_mul_f32 v105, v105, v101
v_mul_f32 v106, v106, v102
v_mul_f32 v107, v107, v103
v_cvt_pk_bf16_f32 v9, v104, v105
v_lshlrev_b32 v104, 16, v9
v_and_b32 v105, s91, v9
v_cvt_pk_bf16_f32 v9, v106, v107
v_lshlrev_b32 v106, 16, v9
v_and_b32 v107, s91, v9
s_waitcnt vmcnt(0)
v_lshlrev_b32 v100, 16, v66
v_and_b32 v101, s91, v66
v_lshlrev_b32 v102, 16, v67
v_and_b32 v103, s91, v67
v_add_f32 v104, v104, v100
v_add_f32 v105, v105, v101
v_add_f32 v106, v106, v102
v_add_f32 v107, v107, v103
v_cvt_pk_bf16_f32 v70, v104, v105
v_cvt_pk_bf16_f32 v71, v106, v107
v_bfe_u32 v9, v41, 0, 8
v_sub_u32 v9, 254, v9
v_lshlrev_b32 v9, 23, v9
v_mul_f32 v100, v32, v9
v_bfe_u32 v9, v41, 8, 8
v_sub_u32 v9, 254, v9
v_lshlrev_b32 v9, 23, v9
v_mul_f32 v101, v33, v9
v_bfe_u32 v9, v41, 16, 8
v_sub_u32 v9, 254, v9
v_lshlrev_b32 v9, 23, v9
v_mul_f32 v102, v34, v9
v_bfe_u32 v9, v41, 24, 8
v_sub_u32 v9, 254, v9
v_lshlrev_b32 v9, 23, v9
v_mul_f32 v103, v35, v9
v_cvt_pk_bf16_f32 v9, v100, v101
v_lshlrev_b32 v100, 16, v9
v_and_b32 v101, s91, v9
v_cvt_pk_bf16_f32 v9, v102, v103
v_lshlrev_b32 v102, 16, v9
v_and_b32 v103, s91, v9
v_mul_f32 v104, s36, v100
v_fmac_f32 v104, s40, v101
v_fmac_f32 v104, s44, v102
v_fmac_f32 v104, s48, v103
v_mul_f32 v105, s37, v100
v_fmac_f32 v105, s41, v101
v_fmac_f32 v105, s45, v102
v_fmac_f32 v105, s49, v103
v_mul_f32 v106, s38, v100
v_fmac_f32 v106, s42, v101
v_fmac_f32 v106, s46, v102
v_fmac_f32 v106, s50, v103
v_mul_f32 v107, s39, v100
v_fmac_f32 v107, s43, v101
v_fmac_f32 v107, s47, v102
v_fmac_f32 v107, s51, v103
v_cvt_pk_bf16_f32 v9, v104, v105
v_lshlrev_b32 v104, 16, v9
v_and_b32 v105, s91, v9
v_cvt_pk_bf16_f32 v9, v106, v107
v_lshlrev_b32 v106, 16, v9
v_and_b32 v107, s91, v9
v_lshlrev_b32 v100, 16, v38
v_and_b32 v101, s91, v38
v_lshlrev_b32 v102, 16, v39
v_and_b32 v103, s91, v39
v_mul_f32 v104, v104, v100
v_mul_f32 v105, v105, v101
v_mul_f32 v106, v106, v102
v_mul_f32 v107, v107, v103
v_cvt_pk_bf16_f32 v9, v104, v105
v_lshlrev_b32 v104, 16, v9
v_and_b32 v105, s91, v9
v_cvt_pk_bf16_f32 v9, v106, v107
v_lshlrev_b32 v106, 16, v9
v_and_b32 v107, s91, v9
v_lshlrev_b32 v100, 16, v68
v_and_b32 v101, s91, v68
v_lshlrev_b32 v102, 16, v69
v_and_b32 v103, s91, v69
v_add_f32 v104, v104, v100
v_add_f32 v105, v105, v101
v_add_f32 v106, v106, v102
v_add_f32 v107, v107, v103
v_cvt_pk_bf16_f32 v72, v104, v105
v_cvt_pk_bf16_f32 v73, v106, v107
buffer_store_dwordx2 v[70:71], v3, s[24:27], 0 offen
v_cmp_gt_u32 vcc, 226, v0
s_and_saveexec_b64 s[96:97], vcc
buffer_store_dwordx2 v[72:73], v4, s[24:27], 0 offen
L_k2_end:
s_endpgm
.section .rodata,"a"
.p2align 6
.amdhsa_kernel gs_bin_kernel
  .amdhsa_next_free_vgpr 128
  .amdhsa_next_free_sgpr 100
  .amdhsa_accum_offset 128
  .amdhsa_group_segment_fixed_size 0
  .amdhsa_kernarg_size 112
  .amdhsa_user_sgpr_count 2
  .amdhsa_user_sgpr_kernarg_segment_ptr 1
  .amdhsa_system_sgpr_workgroup_id_x 1
.end_amdhsa_kernel

.p2align 6
.amdhsa_kernel gather_scatter__molecular_angular_gemnet__graph_kernel
  .amdhsa_next_free_vgpr 128
  .amdhsa_next_free_sgpr 102
  .amdhsa_accum_offset 128
  .amdhsa_group_segment_fixed_size 0
  .amdhsa_kernarg_size 112
  .amdhsa_user_sgpr_count 2
  .amdhsa_user_sgpr_kernarg_segment_ptr 1
  .amdhsa_system_sgpr_workgroup_id_x 1
.end_amdhsa_kernel
```
